```python
import torch

def _softmax(x, axis=-1):
    return torch.softmax(x, dim=axis)
def _gelu(x):
    return torch.nn.functional.gelu(x, approximate="tanh")
def _silu(x):
    return torch.nn.functional.silu(x)
def _sigmoid(x):
    return torch.sigmoid(x)
def _layernorm(x, axis=-1, eps=1e-5):
    m = x.mean(dim=axis, keepdim=True)
    v = x.var(dim=axis, keepdim=True, unbiased=False)
    return (x - m) / torch.sqrt(v + eps)
def _scatter_add(tgt, idx, src, axis=0):
    return tgt.clone().index_add_(axis, idx, src)
def _segment_sum(src, seg, n):
    out = torch.zeros((n,) + src.shape[1:], dtype=src.dtype)
    return out.index_add_(0, seg, src)
def _pad(x, pw):
    flat = tuple(v for pair in reversed(pw) for v in pair)
    return torch.nn.functional.pad(x, flat)

kernel_name = 'standalone__controlnet__diffusion'

def setup_inputs():

    _w = (lambda a: (lambda t: t.to(torch.bfloat16) if t.is_floating_point() else t)(torch.as_tensor(a)))
    B, HW, C = 2, 128, 128
    sc = C ** -0.5
    return {
        "x_frozen": _w((lambda *s: torch.randn(*s, dtype=torch.bfloat16) * 0.05)(B, HW, HW, C)),
        "x": _w((lambda *s: torch.randn(*s, dtype=torch.bfloat16) * 0.1)(B, HW, HW, C)),
        "c": _w((lambda *s: torch.randn(*s, dtype=torch.bfloat16) * 0.4)(B, HW, HW, C)),
        "w_z1": _w((lambda *s: torch.randn(*s, dtype=torch.bfloat16) * 0.4)(C, C) * sc),
        "w_z2": _w((lambda *s: torch.randn(*s, dtype=torch.bfloat16) * 0.1)(C, C) * sc),
        "w_conv": _w((lambda *s: torch.randn(*s, dtype=torch.bfloat16) * 0.1)(3, 3, C, C) * sc / 3.0),
    }

def reference(x_frozen, x, c, w_z1, w_z2, w_conv):
    B, H, W, C = x.shape
    h_in = x + torch.einsum("bhwc,cd->bhwd", c, w_z1)
    h = _silu(_layernorm(h_in, axis=-1))
    hp = _pad(h, ((0, 0), (1, 1), (1, 1), (0, 0)))
    acc = h * 0.0
    for di in range(3):
        for dj in range(3):
            acc = acc + torch.einsum("bhwc,cd->bhwd", hp[:, di:di + H, dj:dj + W, :], w_conv[di, dj])
    h = h_in + acc
    return x_frozen + torch.einsum("bhwc,cd->bhwd", h, w_z2)
```

```asm
; @launch grid=(256,1,1) block=(256,1,1) lds=161920
.amdgcn_target "amdgcn-amd-amdhsa--gfx950"
.text
.globl standalone__controlnet__diffusion_kernel
.p2align 8
.type standalone__controlnet__diffusion_kernel,@function
standalone__controlnet__diffusion_kernel:
  s_cmp_ge_u32 s2, 256
  s_cbranch_scc1 L_end
  s_load_dwordx16 s[4:19], s[0:1], 0
  v_and_b32 v96, 63, v0
  v_lshrrev_b32 v100, 6, v0
  s_nop 0
  v_readfirstlane_b32 s52, v100
  v_and_b32 v97, 31, v0
  v_bfe_u32 v99, v0, 5, 1
  s_and_b32 s70, s2, 7
  s_lshl_b32 s70, s70, 5
  s_lshr_b32 s71, s2, 3
  s_add_u32 s70, s70, s71
  s_lshr_b32 s72, s70, 3
  s_lshl_b32 s53, s72, 18
  s_and_b32 s60, s72, 15
  s_lshl_b32 s60, s60, 3
  s_and_b32 s61, s70, 7
  s_lshl_b32 s72, s61, 12
  s_lshl_b32 s61, s61, 4
  s_add_u32 s53, s53, s72
  s_mov_b32 s66, s53
  s_add_u32 s67, s53, 32768
  s_add_u32 s68, s53, 65536
  s_add_u32 s69, s53, 98304
  s_lshl_b32 s56, s52, 11
  s_lshl_b32 s57, s52, 6
  s_lshr_b32 s70, s52, 1
  s_lshl_b32 s70, s70, 17
  s_and_b32 s71, s52, 1
  s_lshl_b32 s71, s71, 3
  v_lshrrev_b32 v102, 4, v96
  v_add_u32 v100, s71, v102
  v_and_b32 v101, 15, v96
  v_xor_b32 v98, v101, v100
  v_lshlrev_b32 v98, 4, v98
  v_lshl_add_u32 v98, v100, 8, v98
  v_add_u32 v2, s70, v98
  v_add_u32 v100, 4, v100
  v_xor_b32 v98, v101, v100
  v_lshlrev_b32 v98, 4, v98
  v_lshl_add_u32 v98, v100, 8, v98
  v_add_u32 v98, s70, v98
  v_subrev_u32 v3, 1024, v98
  v_bfe_u32 v100, v96, 2, 2
  v_xor_b32 v100, v100, v102
  v_lshlrev_b32 v100, 6, v100
  v_lshl_add_u32 v100, v102, 8, v100
  v_and_b32 v101, 3, v96
  v_lshl_add_u32 v103, v101, 4, v100
  v_lshrrev_b32 v100, 2, v96
  v_lshlrev_b32 v100, 8, v100
  v_lshl_add_u32 v100, v101, 4, v100
  v_add_u32 v4, s57, v100
  v_add_u32 v92, 97280, v4
  v_add_u32 v93, 194560, v4
  v_add_u32 v94, 3072, v4
  v_add_u32 v95, 6144, v4
  v_lshlrev_b32 v104, 4, v96
  s_mul_i32 s72, s52, 15360
  s_add_u32 s54, s72, 100480
  s_lshl_b32 s55, s52, 13
  s_waitcnt lgkmcnt(0)
  s_mov_b32 s28, s8
  s_mov_b32 s29, s9
  s_mov_b32 s30, 8388608
  s_mov_b32 s31, 0x00020000
  s_mov_b32 s24, s6
  s_mov_b32 s25, s7
  s_mov_b32 s26, 8388608
  s_mov_b32 s27, 0x00020000
  s_mov_b32 s36, s10
  s_mov_b32 s37, s11
  s_mov_b32 s38, 32768
  s_mov_b32 s39, 0x00020000
  s_add_u32 m0, s56, 0
  s_nop 0
  buffer_load_dwordx4 v2, s[28:31], s66 offen nt lds
  buffer_load_dwordx4 v3, s[28:31], s66 offen offset:1024 nt lds
  s_add_u32 m0, s56, 8192
  s_nop 0
  buffer_load_dwordx4 v2, s[24:27], s66 offen nt lds
  buffer_load_dwordx4 v3, s[24:27], s66 offen offset:1024 nt lds
  s_add_u32 m0, s55, 49152
  s_add_u32 s70, s55, 0
  buffer_load_dwordx4 v103, s[36:39], s70 offen lds
  buffer_load_dwordx4 v103, s[36:39], s70 offen offset:1024 lds
  buffer_load_dwordx4 v103, s[36:39], s70 offen offset:2048 lds
  buffer_load_dwordx4 v103, s[36:39], s70 offen offset:3072 lds
  s_add_u32 m0, s55, 53248
  s_add_u32 s70, s55, 4096
  buffer_load_dwordx4 v103, s[36:39], s70 offen lds
  buffer_load_dwordx4 v103, s[36:39], s70 offen offset:1024 lds
  buffer_load_dwordx4 v103, s[36:39], s70 offen offset:2048 lds
  buffer_load_dwordx4 v103, s[36:39], s70 offen offset:3072 lds
  s_mov_b32 s44, s14
  s_mov_b32 s45, s15
  s_mov_b32 s46, 294912
  s_mov_b32 s47, 0x00020000
  s_mov_b32 s40, s12
  s_mov_b32 s41, s13
  s_mov_b32 s42, 32768
  s_mov_b32 s43, 0x00020000
  v_bfe_u32 v101, v96, 4, 1
  v_lshlrev_b32 v100, 5, v101
  v_and_b32 v101, 1, v96
  v_lshl_add_u32 v100, v101, 4, v100
  v_bfe_u32 v101, v96, 1, 1
  v_lshl_add_u32 v100, v101, 3, v100
  v_bfe_u32 v101, v96, 2, 2
  v_lshl_add_u32 v98, v99, 3, v101
  v_lshl_add_u32 v102, v98, 6, v100
  v_add_u32 v5, s54, v102
  v_lshl_add_u32 v102, v98, 8, v100
  v_xor_b32 v101, s52, v101
  v_lshl_add_u32 v102, v101, 6, v102
  v_add_u32 v6, 49152, v102
  v_lshrrev_b32 v100, 4, v97
  v_mul_u32_u24 v100, 19712, v100
  v_and_b32 v101, 15, v97
  v_mul_u32_u24 v98, 272, v101
  v_lshl_add_u32 v98, v99, 4, v98
  v_add_u32 v100, v100, v98
  v_add_u32 v7, 49152, v100
  v_add_u32 v100, 5200, v7
  v_add_u32 v16, s57, v100
  v_xor_b32 v100, v99, v101
  v_lshlrev_b32 v100, 4, v100
  v_lshl_add_u32 v8, v97, 8, v100
  v_xor_b32 v9, 32, v8
  v_xor_b32 v10, 64, v8
  v_xor_b32 v11, 96, v8
  v_xor_b32 v12, 128, v8
  v_xor_b32 v13, 160, v8
  v_xor_b32 v14, 192, v8
  v_xor_b32 v15, 224, v8
  v_xor_b32 v21, s57, v8
  v_xor_b32 v22, 32, v21
  v_add_u32 v1, s56, v104
  s_lshl_b32 s70, s52, 2
  s_add_u32 s70, s70, 98432
  v_add_u32 v19, s70, v104
  v_lshlrev_b32 v100, 4, v97
  v_add_u32 v20, 98432, v100
  v_bfe_u32 v100, v97, 3, 1
  v_and_b32 v101, 3, v97
  v_lshl_add_u32 v100, v100, 2, v101
  v_and_b32 v101, 1, v100
  v_lshlrev_b32 v101, 4, v101
  s_mov_b32 s70, 0x3f80
  v_lshlrev_b32 v101, v101, s70
  v_lshrrev_b32 v100, 1, v100
  v_lshrrev_b32 v98, 4, v97
  v_lshl_add_u32 v100, v98, 2, v100
  v_bfe_u32 v98, v97, 2, 1
  v_mov_b32 v102, 63
  v_cmp_eq_u32 vcc, v98, v99
  s_nop 1
  v_cndmask_b32 v100, v102, v100, vcc
  v_cmp_eq_u32 s[90:91], 0, v100
  v_cmp_eq_u32 s[92:93], 1, v100
  v_cmp_eq_u32 s[94:95], 2, v100
  v_cmp_eq_u32 s[96:97], 3, v100
  v_cndmask_b32 v56, 0, v101, s[90:91]
  v_cndmask_b32 v57, 0, v101, s[92:93]
  v_cndmask_b32 v58, 0, v101, s[94:95]
  v_cndmask_b32 v59, 0, v101, s[96:97]
  v_cmp_eq_u32 s[90:91], 4, v100
  v_cmp_eq_u32 s[92:93], 5, v100
  v_cmp_eq_u32 s[94:95], 6, v100
  v_cmp_eq_u32 s[96:97], 7, v100
  v_cndmask_b32 v60, 0, v101, s[90:91]
  v_cndmask_b32 v61, 0, v101, s[92:93]
  v_cndmask_b32 v62, 0, v101, s[94:95]
  v_cndmask_b32 v63, 0, v101, s[96:97]
  s_mov_b32 s62, 0x3fb8aa3b
  s_mov_b32 s63, 0x3c000000
  s_mov_b32 s64, 0x3727c5ac
  s_sub_u32 s65, s53, 33024
  s_sub_u32 s58, s60, 1
  s_sub_u32 s59, s61, 1
  v_mov_b32 v105, 0x7f000000
  s_lshl_b32 s71, s52, 3
  s_add_u32 s71, s71, 0
  v_lshrrev_b32 v109, 4, v96
  v_add_u32 v109, s71, v109
  v_cmp_gt_u32 vcc, 16, v109
  v_lshrrev_b32 v106, 1, v109
  v_add_u32 v106, 1, v106
  v_and_b32 v107, 1, v109
  v_mul_u32_u24 v107, 17, v107
  v_subrev_u32 v108, 16, v109
  v_cndmask_b32 v106, 0, v106, vcc
  v_cndmask_b32 v107, v108, v107, vcc
  v_add_u32 v108, s58, v106
  v_add_u32 v111, s59, v107
  v_max_u32 v108, v108, v111
  v_cmp_gt_u32 vcc, 128, v108
  v_lshlrev_b32 v64, 15, v106
  v_lshl_add_u32 v64, v107, 8, v64
  v_add_u32 v64, s65, v64
  v_xor_b32 v110, v109, v96
  v_and_b32 v110, 15, v110
  v_lshl_add_u32 v64, v110, 4, v64
  v_cndmask_b32 v64, v105, v64, vcc
  s_lshl_b32 s71, s52, 3
  s_add_u32 s71, s71, 4
  v_lshrrev_b32 v109, 4, v96
  v_add_u32 v109, s71, v109
  v_cmp_gt_u32 vcc, 16, v109
  v_lshrrev_b32 v106, 1, v109
  v_add_u32 v106, 1, v106
  v_and_b32 v107, 1, v109
  v_mul_u32_u24 v107, 17, v107
  v_subrev_u32 v108, 16, v109
  v_cndmask_b32 v106, 0, v106, vcc
  v_cndmask_b32 v107, v108, v107, vcc
  v_add_u32 v108, s58, v106
  v_add_u32 v111, s59, v107
  v_max_u32 v108, v108, v111
  v_cmp_gt_u32 vcc, 128, v108
  v_lshlrev_b32 v65, 15, v106
  v_lshl_add_u32 v65, v107, 8, v65
  v_add_u32 v65, s65, v65
  v_xor_b32 v110, v109, v96
  v_and_b32 v110, 15, v110
  v_lshl_add_u32 v65, v110, 4, v65
  v_subrev_u32 v65, 1024, v65
  v_cndmask_b32 v65, v105, v65, vcc
  s_mov_b32 s20, s4
  s_mov_b32 s21, s5
  s_mov_b32 s22, 8388608
  s_mov_b32 s23, 0x00020000
  s_mov_b32 s32, s16
  s_mov_b32 s33, s17
  s_mov_b32 s34, 8388608
  s_mov_b32 s35, 0x00020000
  s_lshl_b32 s71, s52, 3
  s_add_u32 s71, s71, 0
  v_lshrrev_b32 v109, 4, v96
  v_add_u32 v109, s71, v109
  v_cmp_gt_u32 vcc, 18, v109
  v_subrev_u32 v108, 2, v109
  v_mov_b32 v106, 9
  v_cndmask_b32 v106, 0, v106, vcc
  v_cndmask_b32 v107, v108, v109, vcc
  v_cmp_gt_u32 vcc, 20, v109
  v_mov_b32 v108, 64
  s_nop 0
  v_cndmask_b32 v106, v108, v106, vcc
  v_add_u32 v108, s58, v106
  v_add_u32 v111, s59, v107
  v_max_u32 v108, v108, v111
  v_lshlrev_b32 v111, 3, v106
  v_max_u32 v108, v108, v111
  v_cmp_gt_u32 vcc, 128, v108
  v_lshlrev_b32 v66, 15, v106
  v_lshl_add_u32 v66, v107, 8, v66
  v_add_u32 v66, s65, v66
  v_xor_b32 v110, v109, v96
  v_and_b32 v110, 15, v110
  v_lshl_add_u32 v66, v110, 4, v66
  v_cndmask_b32 v66, v105, v66, vcc
  s_lshl_b32 s71, s52, 3
  s_add_u32 s71, s71, 4
  v_lshrrev_b32 v109, 4, v96
  v_add_u32 v109, s71, v109
  v_cmp_gt_u32 vcc, 18, v109
  v_subrev_u32 v108, 2, v109
  v_mov_b32 v106, 9
  v_cndmask_b32 v106, 0, v106, vcc
  v_cndmask_b32 v107, v108, v109, vcc
  v_cmp_gt_u32 vcc, 20, v109
  v_mov_b32 v108, 64
  s_nop 0
  v_cndmask_b32 v106, v108, v106, vcc
  v_add_u32 v108, s58, v106
  v_add_u32 v111, s59, v107
  v_max_u32 v108, v108, v111
  v_lshlrev_b32 v111, 3, v106
  v_max_u32 v108, v108, v111
  v_cmp_gt_u32 vcc, 128, v108
  v_lshlrev_b32 v67, 15, v106
  v_lshl_add_u32 v67, v107, 8, v67
  v_add_u32 v67, s65, v67
  v_xor_b32 v110, v109, v96
  v_and_b32 v110, 15, v110
  v_lshl_add_u32 v67, v110, 4, v67
  v_subrev_u32 v67, 1024, v67
  v_cndmask_b32 v67, v105, v67, vcc
  v_cmp_gt_u32 vcc, 16, v97
  v_lshrrev_b32 v106, 1, v97
  v_add_u32 v106, 1, v106
  v_and_b32 v107, 1, v97
  v_mul_u32_u24 v107, 17, v107
  v_subrev_u32 v108, 16, v97
  v_cndmask_b32 v106, 0, v106, vcc
  v_cndmask_b32 v107, v108, v107, vcc
  v_mul_u32_u24 v17, 4928, v106
  v_mul_u32_u24 v108, 272, v107
  v_add3_u32 v17, v17, v108, s57
  v_lshl_add_u32 v17, v99, 4, v17
  v_add_u32 v17, 49152, v17
  v_cmp_gt_u32 vcc, 18, v97
  v_subrev_u32 v108, 2, v97
  v_mov_b32 v106, 9
  v_cndmask_b32 v106, 0, v106, vcc
  v_cndmask_b32 v107, v108, v97, vcc
  v_cmp_gt_u32 vcc, 20, v97
  v_mov_b32 v108, 64
  s_nop 0
  v_cndmask_b32 v106, v108, v106, vcc
  v_cmp_gt_u32 vcc, 10, v106
  v_mul_u32_u24 v18, 4928, v106
  v_mul_u32_u24 v108, 272, v107
  v_add3_u32 v18, v18, v108, s57
  v_lshl_add_u32 v18, v99, 4, v18
  v_add_u32 v18, 49152, v18
  v_mov_b32 v108, 32768
  v_cndmask_b32 v18, v108, v18, vcc
  s_add_u32 m0, s56, 16384
  s_nop 0
  buffer_load_dwordx4 v2, s[28:31], s67 offen nt lds
  buffer_load_dwordx4 v3, s[28:31], s67 offen offset:1024 nt lds
  s_add_u32 m0, s56, 24576
  s_nop 0
  buffer_load_dwordx4 v2, s[24:27], s67 offen nt lds
  buffer_load_dwordx4 v3, s[24:27], s67 offen offset:1024 nt lds
  s_waitcnt vmcnt(4)
  s_barrier
  ds_read_b64_tr_b16 v[192:193], v6 offset:0
  ds_read_b64_tr_b16 v[194:195], v6 offset:1024
  ds_read_b64_tr_b16 v[196:197], v6 offset:4096
  ds_read_b64_tr_b16 v[198:199], v6 offset:5120
  ds_read_b64_tr_b16 v[200:201], v6 offset:8192
  ds_read_b64_tr_b16 v[202:203], v6 offset:9216
  ds_read_b64_tr_b16 v[204:205], v6 offset:12288
  ds_read_b64_tr_b16 v[206:207], v6 offset:13312
  ds_read_b64_tr_b16 v[208:209], v6 offset:16384
  ds_read_b64_tr_b16 v[210:211], v6 offset:17408
  ds_read_b64_tr_b16 v[212:213], v6 offset:20480
  ds_read_b64_tr_b16 v[214:215], v6 offset:21504
  ds_read_b64_tr_b16 v[216:217], v6 offset:24576
  ds_read_b64_tr_b16 v[218:219], v6 offset:25600
  ds_read_b64_tr_b16 v[220:221], v6 offset:28672
  ds_read_b64_tr_b16 v[222:223], v6 offset:29696
  ds_read_b128 v[32:35], v8 offset:0
  ds_read_b128 v[36:39], v9 offset:0
  ds_read_b128 v[40:43], v10 offset:0
  ds_read_b128 v[44:47], v11 offset:0
  ds_read_b128 v[48:51], v12 offset:0
  s_add_u32 m0, s54, 0
  s_mov_b32 s73, 32768
  buffer_load_dwordx4 v4, s[44:47], s73 offen lds
  buffer_load_dwordx4 v92, s[44:47], s73 offen offset:1024 lds
  s_waitcnt lgkmcnt(3)
  v_mfma_f32_32x32x16_bf16 v[128:143], v[192:195], v[32:35], 0
  ds_read_b128 v[52:55], v13 offset:0
  buffer_load_dwordx4 v93, s[44:47], s73 offen offset:2048 lds
  s_add_u32 m0, s56, 32768
  s_nop 0
  buffer_load_dwordx4 v2, s[28:31], s68 offen nt lds
  v_mfma_f32_32x32x16_bf16 v[128:143], v[196:199], v[36:39], v[128:143]
  ds_read_b128 v[32:35], v14 offset:0
  s_add_u32 m0, s56, 32768
  s_nop 0
  buffer_load_dwordx4 v3, s[28:31], s68 offen offset:1024 nt lds
  s_waitcnt lgkmcnt(3)
  v_mfma_f32_32x32x16_bf16 v[128:143], v[200:203], v[40:43], v[128:143]
  ds_read_b128 v[36:39], v15 offset:0
  s_add_u32 m0, s56, 40960
  s_nop 0
  buffer_load_dwordx4 v2, s[24:27], s68 offen nt lds
  v_mfma_f32_32x32x16_bf16 v[128:143], v[204:207], v[44:47], v[128:143]
  ds_read_b128 v[40:43], v21 offset:8192
  s_add_u32 m0, s56, 40960
  s_nop 0
  buffer_load_dwordx4 v3, s[24:27], s68 offen offset:1024 nt lds
  s_waitcnt lgkmcnt(3)
  v_mfma_f32_32x32x16_bf16 v[128:143], v[208:211], v[48:51], v[128:143]
  ds_read_b128 v[44:47], v22 offset:8192
  s_lshr_b32 s71, s2, 3
  s_mul_i32 s70, s71, 9216
  s_lshl_b32 s72, s52, 10
  s_add_u32 s70, s70, s72
  buffer_load_dwordx4 a[240:243], v104, s[44:47], s70 offen
  s_add_u32 s70, s70, 4096
  buffer_load_dwordx4 a[244:247], v104, s[44:47], s70 offen
  v_and_b32 v100, 240, v104
  s_mul_i32 s70, s71, 9216
  s_lshl_b32 s72, s52, 8
  s_add_u32 s70, s70, s72
  s_add_u32 s70, s70, 8192
  buffer_load_dwordx4 a[248:251], v100, s[44:47], s70 offen
  s_lshl_b32 s70, s71, 10
  s_add_u32 s70, s70, s72
  buffer_load_dwordx4 a[252:255], v100, s[40:43], s70 offen
  buffer_load_dwordx4 a[236:239], v100, s[36:39], s70 offen
  v_mfma_f32_32x32x16_bf16 v[128:143], v[212:215], v[52:55], v[128:143]
  s_waitcnt lgkmcnt(2)
  v_mfma_f32_32x32x16_bf16 v[128:143], v[216:219], v[32:35], v[128:143]
  v_mfma_f32_32x32x16_bf16 v[128:143], v[220:223], v[36:39], v[128:143]
  s_waitcnt lgkmcnt(1)
  v_mfma_f32_32x32x16_bf16 v[128:143], v[56:59], v[40:43], v[128:143]
  s_waitcnt lgkmcnt(0)
  v_mfma_f32_32x32x16_bf16 v[128:143], v[60:63], v[44:47], v[128:143]
  s_nop 11
  v_add_f32 v23, v128, v129
  v_mul_f32 v24, v128, v128
  v_fmac_f32 v24, v129, v129
  v_add_f32 v23, v23, v130
  v_fmac_f32 v24, v130, v130
  v_add_f32 v23, v23, v131
  v_fmac_f32 v24, v131, v131
  v_add_f32 v23, v23, v132
  v_fmac_f32 v24, v132, v132
  v_add_f32 v23, v23, v133
  v_fmac_f32 v24, v133, v133
  v_add_f32 v23, v23, v134
  v_fmac_f32 v24, v134, v134
  v_add_f32 v23, v23, v135
  v_fmac_f32 v24, v135, v135
  v_add_f32 v23, v23, v136
  v_fmac_f32 v24, v136, v136
  v_add_f32 v23, v23, v137
  v_fmac_f32 v24, v137, v137
  v_add_f32 v23, v23, v138
  v_fmac_f32 v24, v138, v138
  v_add_f32 v23, v23, v139
  v_fmac_f32 v24, v139, v139
  v_add_f32 v23, v23, v140
  v_fmac_f32 v24, v140, v140
  v_add_f32 v23, v23, v141
  v_fmac_f32 v24, v141, v141
  v_add_f32 v23, v23, v142
  v_fmac_f32 v24, v142, v142
  v_add_f32 v23, v23, v143
  v_fmac_f32 v24, v143, v143
  s_nop 1
  v_permlane32_swap_b32 v23, v24
  v_add_f32 v23, v23, v24
  ds_write_b32 v19, v23 offset:0
  s_waitcnt vmcnt(12) lgkmcnt(0)
  s_barrier
  ds_read_b128 v[68:71], v20 offset:0
  ds_read_b128 v[72:75], v20 offset:512
  ds_read_b128 v[48:51], v8 offset:16384
  ds_read_b128 v[52:55], v9 offset:16384
  ds_read_b128 v[32:35], v10 offset:16384
  ds_read_b128 v[36:39], v11 offset:16384
  ds_read_b128 v[40:43], v12 offset:16384
  s_waitcnt vmcnt(9)
  ds_read_b64_tr_b16 a[0:1], v5 offset:0
  ds_read_b64_tr_b16 a[2:3], v5 offset:256
  ds_read_b64_tr_b16 a[4:5], v5 offset:1024
  ds_read_b64_tr_b16 a[6:7], v5 offset:1280
  ds_read_b64_tr_b16 a[8:9], v5 offset:2048
  ds_read_b64_tr_b16 a[10:11], v5 offset:2304
  s_waitcnt lgkmcnt(9)
  v_mfma_f32_32x32x16_bf16 v[144:159], v[192:195], v[48:51], 0
  ds_read_b128 v[44:47], v13 offset:16384
  s_add_u32 m0, s54, 3072
  s_mov_b32 s73, 36864
  buffer_load_dwordx4 v4, s[44:47], s73 offen lds
  v_mfma_f32_32x32x16_bf16 v[144:159], v[196:199], v[52:55], v[144:159]
  ds_read_b128 v[48:51], v14 offset:16384
  buffer_load_dwordx4 v92, s[44:47], s73 offen offset:1024 lds
  v_add_f32 v68, v68, v69
  v_add_f32 v72, v72, v73
  v_add_f32 v70, v70, v71
  v_add_f32 v74, v74, v75
  v_add_f32 v68, v68, v70
  v_add_f32 v72, v72, v74
  s_waitcnt lgkmcnt(9)
  v_mfma_f32_32x32x16_bf16 v[144:159], v[200:203], v[32:35], v[144:159]
  ds_read_b128 v[52:55], v15 offset:16384
  v_mul_f32 v29, s63, v68
  v_mul_f32 v31, s63, v72
  v_fma_f32 v31, -v29, v29, v31
  v_max_f32 v31, 0, v31
  v_add_f32 v31, s64, v31
  v_rsq_f32 v31, v31
  s_nop 0
  v_mul_f32 v28, s62, v31
  v_mul_f32 v30, -v29, v28
  v_mfma_f32_32x32x16_bf16 v[144:159], v[204:207], v[36:39], v[144:159]
  ds_read_b128 v[32:35], v21 offset:24576
  buffer_load_dwordx4 v93, s[44:47], s73 offen offset:2048 lds
  s_add_u32 m0, s54, 6144
  s_mov_b32 s73, 40960
  buffer_load_dwordx4 v4, s[44:47], s73 offen lds
  v_pk_fma_f32 v[224:225], v[128:129], v[28:29], v[30:31] op_sel_hi:[1,0,0]
  v_pk_fma_f32 v[226:227], v[130:131], v[28:29], v[30:31] op_sel_hi:[1,0,0]
  v_pk_fma_f32 v[228:229], v[132:133], v[28:29], v[30:31] op_sel_hi:[1,0,0]
  v_pk_fma_f32 v[230:231], v[134:135], v[28:29], v[30:31] op_sel_hi:[1,0,0]
  v_pk_fma_f32 v[232:233], v[136:137], v[28:29], v[30:31] op_sel_hi:[1,0,0]
  v_pk_fma_f32 v[234:235], v[138:139], v[28:29], v[30:31] op_sel_hi:[1,0,0]
  v_pk_fma_f32 v[236:237], v[140:141], v[28:29], v[30:31] op_sel_hi:[1,0,0]
  v_pk_fma_f32 v[238:239], v[142:143], v[28:29], v[30:31] op_sel_hi:[1,0,0]
  s_waitcnt lgkmcnt(3)
  v_mfma_f32_32x32x16_bf16 v[144:159], v[208:211], v[40:43], v[144:159]
  ds_read_b128 v[36:39], v22 offset:24576
  v_exp_f32 v240, -v224
  v_exp_f32 v241, -v225
  v_exp_f32 v242, -v226
  v_mfma_f32_32x32x16_bf16 v[144:159], v[212:215], v[44:47], v[144:159]
  v_exp_f32 v243, -v227
  v_exp_f32 v244, -v228
  v_exp_f32 v245, -v229
  s_waitcnt lgkmcnt(2)
  v_mfma_f32_32x32x16_bf16 v[144:159], v[216:219], v[48:51], v[144:159]
  v_exp_f32 v246, -v230
  v_exp_f32 v247, -v231
  v_exp_f32 v248, -v232
  v_mfma_f32_32x32x16_bf16 v[144:159], v[220:223], v[52:55], v[144:159]
  v_exp_f32 v249, -v233
  v_exp_f32 v250, -v234
  v_exp_f32 v251, -v235
  s_waitcnt lgkmcnt(1)
  v_mfma_f32_32x32x16_bf16 v[144:159], v[56:59], v[32:35], v[144:159]
  v_exp_f32 v252, -v236
  v_exp_f32 v253, -v237
  v_exp_f32 v254, -v238
  v_exp_f32 v255, -v239
  s_waitcnt lgkmcnt(0)
  v_mfma_f32_32x32x16_bf16 v[144:159], v[60:63], v[36:39], v[144:159]
  buffer_load_dwordx4 v92, s[44:47], s73 offen offset:1024 lds
  buffer_load_dwordx4 v93, s[44:47], s73 offen offset:2048 lds
  s_add_u32 m0, s56, 0
  s_nop 0
  buffer_load_dwordx4 v2, s[28:31], s69 offen nt lds
  v_pk_fma_f32 v[240:241], v[240:241], s[62:63], s[62:63] op_sel_hi:[1,0,0]
  v_pk_fma_f32 v[242:243], v[242:243], s[62:63], s[62:63] op_sel_hi:[1,0,0]
  v_pk_fma_f32 v[244:245], v[244:245], s[62:63], s[62:63] op_sel_hi:[1,0,0]
  v_pk_fma_f32 v[246:247], v[246:247], s[62:63], s[62:63] op_sel_hi:[1,0,0]
  v_pk_fma_f32 v[248:249], v[248:249], s[62:63], s[62:63] op_sel_hi:[1,0,0]
  v_pk_fma_f32 v[250:251], v[250:251], s[62:63], s[62:63] op_sel_hi:[1,0,0]
  v_pk_fma_f32 v[252:253], v[252:253], s[62:63], s[62:63] op_sel_hi:[1,0,0]
  v_pk_fma_f32 v[254:255], v[254:255], s[62:63], s[62:63] op_sel_hi:[1,0,0]
  v_pk_add_f32 v[24:25], v[144:145], v[146:147]
  v_pk_mul_f32 v[26:27], v[144:145], v[144:145]
  v_pk_fma_f32 v[26:27], v[146:147], v[146:147], v[26:27]
  v_pk_add_f32 v[24:25], v[24:25], v[148:149]
  v_pk_fma_f32 v[26:27], v[148:149], v[148:149], v[26:27]
  v_pk_add_f32 v[24:25], v[24:25], v[150:151]
  v_pk_fma_f32 v[26:27], v[150:151], v[150:151], v[26:27]
  v_pk_add_f32 v[24:25], v[24:25], v[152:153]
  v_pk_fma_f32 v[26:27], v[152:153], v[152:153], v[26:27]
  v_pk_add_f32 v[24:25], v[24:25], v[154:155]
  v_pk_fma_f32 v[26:27], v[154:155], v[154:155], v[26:27]
  v_pk_add_f32 v[24:25], v[24:25], v[156:157]
  v_pk_fma_f32 v[26:27], v[156:157], v[156:157], v[26:27]
  v_pk_add_f32 v[24:25], v[24:25], v[158:159]
  v_pk_fma_f32 v[26:27], v[158:159], v[158:159], v[26:27]
  v_add_f32 v24, v24, v25
  v_add_f32 v26, v26, v27
  s_nop 1
  v_permlane32_swap_b32 v24, v26
  v_add_f32 v24, v24, v26
  ds_write_b32 v19, v24 offset:1024
  v_rcp_f32 v240, v240
  v_rcp_f32 v241, v241
  v_rcp_f32 v242, v242
  v_rcp_f32 v243, v243
  v_rcp_f32 v244, v244
  v_rcp_f32 v245, v245
  v_rcp_f32 v246, v246
  v_rcp_f32 v247, v247
  v_rcp_f32 v248, v248
  v_rcp_f32 v249, v249
  v_rcp_f32 v250, v250
  v_rcp_f32 v251, v251
  v_rcp_f32 v252, v252
  v_rcp_f32 v253, v253
  v_rcp_f32 v254, v254
  v_rcp_f32 v255, v255
  v_pk_mul_f32 v[224:225], v[224:225], v[240:241]
  v_pk_mul_f32 v[226:227], v[226:227], v[242:243]
  v_pk_mul_f32 v[228:229], v[228:229], v[244:245]
  v_pk_mul_f32 v[230:231], v[230:231], v[246:247]
  v_pk_mul_f32 v[232:233], v[232:233], v[248:249]
  v_pk_mul_f32 v[234:235], v[234:235], v[250:251]
  v_pk_mul_f32 v[236:237], v[236:237], v[252:253]
  v_pk_mul_f32 v[238:239], v[238:239], v[254:255]
  v_cvt_pk_bf16_f32 v76, v224, v225
  v_cvt_pk_bf16_f32 v77, v226, v227
  v_cvt_pk_bf16_f32 v78, v228, v229
  v_cvt_pk_bf16_f32 v79, v230, v231
  ds_write_b128 v16, v[76:79] offset:0
  v_cvt_pk_bf16_f32 v80, v232, v233
  v_cvt_pk_bf16_f32 v81, v234, v235
  v_cvt_pk_bf16_f32 v82, v236, v237
  v_cvt_pk_bf16_f32 v83, v238, v239
  ds_write_b128 v16, v[80:83] offset:32
  s_add_u32 m0, s56, 0
  s_nop 0
  buffer_load_dwordx4 v3, s[28:31], s69 offen offset:1024 nt lds
  s_add_u32 m0, s56, 8192
  s_nop 0
  buffer_load_dwordx4 v2, s[24:27], s69 offen nt lds
  s_add_u32 m0, s56, 8192
  s_nop 0
  buffer_load_dwordx4 v3, s[24:27], s69 offen offset:1024 nt lds
  s_waitcnt vmcnt(15) lgkmcnt(0)
  s_barrier
  ds_read_b128 v[68:71], v20 offset:1024
  ds_read_b128 v[72:75], v20 offset:1536
  ds_read_b128 v[40:43], v8 offset:32768
  ds_read_b128 v[44:47], v9 offset:32768
  ds_read_b128 v[48:51], v10 offset:32768
  ds_read_b128 v[52:55], v11 offset:32768
  ds_read_b128 v[32:35], v12 offset:32768
  s_waitcnt vmcnt(7)
  ds_read_b64_tr_b16 a[12:13], v5 offset:3072
  ds_read_b64_tr_b16 a[14:15], v5 offset:3328
  ds_read_b64_tr_b16 a[16:17], v5 offset:4096
  ds_read_b64_tr_b16 a[18:19], v5 offset:4352
  ds_read_b64_tr_b16 a[20:21], v5 offset:5120
  ds_read_b64_tr_b16 a[22:23], v5 offset:5376
  s_waitcnt vmcnt(4)
  ds_read_b64_tr_b16 a[24:25], v5 offset:6144
  ds_read_b64_tr_b16 a[26:27], v5 offset:6400
  ds_read_b64_tr_b16 a[28:29], v5 offset:7168
  ds_read_b64_tr_b16 a[30:31], v5 offset:7424
  ds_read_b64_tr_b16 a[32:33], v5 offset:8192
  ds_read_b64_tr_b16 a[34:35], v5 offset:8448
  s_waitcnt lgkmcnt(15)
  v_mfma_f32_32x32x16_bf16 v[160:175], v[192:195], v[40:43], 0
  ds_read_b128 v[36:39], v13 offset:32768
  s_add_u32 m0, s54, 9216
  s_mov_b32 s73, 45056
  buffer_load_dwordx4 v4, s[44:47], s73 offen lds
  v_mfma_f32_32x32x16_bf16 v[160:175], v[196:199], v[44:47], v[160:175]
  ds_read_b128 v[40:43], v14 offset:32768
  buffer_load_dwordx4 v92, s[44:47], s73 offen offset:1024 lds
  v_add_f32 v68, v68, v69
  v_add_f32 v72, v72, v73
  v_add_f32 v70, v70, v71
  v_add_f32 v74, v74, v75
  v_add_f32 v68, v68, v70
  v_add_f32 v72, v72, v74
  s_waitcnt lgkmcnt(15)
  v_mfma_f32_32x32x16_bf16 v[160:175], v[200:203], v[48:51], v[160:175]
  ds_read_b128 v[44:47], v15 offset:32768
  v_mul_f32 v29, s63, v68
  v_mul_f32 v31, s63, v72
  v_fma_f32 v31, -v29, v29, v31
  v_max_f32 v31, 0, v31
  v_add_f32 v31, s64, v31
  v_rsq_f32 v31, v31
  s_nop 0
  v_mul_f32 v28, s62, v31
  v_mul_f32 v30, -v29, v28
  v_mfma_f32_32x32x16_bf16 v[160:175], v[204:207], v[52:55], v[160:175]
  ds_read_b128 v[48:51], v21 offset:40960
  buffer_load_dwordx4 v93, s[44:47], s73 offen offset:2048 lds
  s_add_u32 m0, s54, 12288
  s_mov_b32 s73, 49152
  buffer_load_dwordx4 v4, s[44:47], s73 offen lds
  v_pk_fma_f32 v[224:225], v[144:145], v[28:29], v[30:31] op_sel_hi:[1,0,0]
  v_pk_fma_f32 v[226:227], v[146:147], v[28:29], v[30:31] op_sel_hi:[1,0,0]
  v_pk_fma_f32 v[228:229], v[148:149], v[28:29], v[30:31] op_sel_hi:[1,0,0]
  v_pk_fma_f32 v[230:231], v[150:151], v[28:29], v[30:31] op_sel_hi:[1,0,0]
  v_pk_fma_f32 v[232:233], v[152:153], v[28:29], v[30:31] op_sel_hi:[1,0,0]
  v_pk_fma_f32 v[234:235], v[154:155], v[28:29], v[30:31] op_sel_hi:[1,0,0]
  v_pk_fma_f32 v[236:237], v[156:157], v[28:29], v[30:31] op_sel_hi:[1,0,0]
  v_pk_fma_f32 v[238:239], v[158:159], v[28:29], v[30:31] op_sel_hi:[1,0,0]
  s_waitcnt lgkmcnt(3)
  v_mfma_f32_32x32x16_bf16 v[160:175], v[208:211], v[32:35], v[160:175]
  ds_read_b128 v[52:55], v22 offset:40960
  v_exp_f32 v240, -v224
  v_exp_f32 v241, -v225
  v_exp_f32 v242, -v226
  v_mfma_f32_32x32x16_bf16 v[160:175], v[212:215], v[36:39], v[160:175]
  ds_read_b128 v[32:35], v7 offset:5200
  v_exp_f32 v243, -v227
  v_exp_f32 v244, -v228
  v_exp_f32 v245, -v229
  s_waitcnt lgkmcnt(3)
  v_mfma_f32_32x32x16_bf16 v[160:175], v[216:219], v[40:43], v[160:175]
  ds_read_b128 v[36:39], v7 offset:5232
  v_exp_f32 v246, -v230
  v_exp_f32 v247, -v231
  v_exp_f32 v248, -v232
  v_mfma_f32_32x32x16_bf16 v[160:175], v[220:223], v[44:47], v[160:175]
  ds_read_b128 v[40:43], v7 offset:5264
  v_exp_f32 v249, -v233
  v_exp_f32 v250, -v234
  v_exp_f32 v251, -v235
  s_waitcnt lgkmcnt(3)
  v_mfma_f32_32x32x16_bf16 v[160:175], v[56:59], v[48:51], v[160:175]
  v_exp_f32 v252, -v236
  v_exp_f32 v253, -v237
  v_exp_f32 v254, -v238
  v_exp_f32 v255, -v239
  v_mfma_f32_32x32x16_bf16 v[160:175], v[60:63], v[52:55], v[160:175]
  buffer_load_dwordx4 v92, s[44:47], s73 offen offset:1024 lds
  buffer_load_dwordx4 v93, s[44:47], s73 offen offset:2048 lds
  s_add_u32 m0, s56, 16384
  s_nop 0
  buffer_load_dwordx4 v64, s[28:31], 0 offen nt lds
  v_pk_fma_f32 v[240:241], v[240:241], s[62:63], s[62:63] op_sel_hi:[1,0,0]
  v_pk_fma_f32 v[242:243], v[242:243], s[62:63], s[62:63] op_sel_hi:[1,0,0]
  v_pk_fma_f32 v[244:245], v[244:245], s[62:63], s[62:63] op_sel_hi:[1,0,0]
  v_pk_fma_f32 v[246:247], v[246:247], s[62:63], s[62:63] op_sel_hi:[1,0,0]
  v_pk_fma_f32 v[248:249], v[248:249], s[62:63], s[62:63] op_sel_hi:[1,0,0]
  v_pk_fma_f32 v[250:251], v[250:251], s[62:63], s[62:63] op_sel_hi:[1,0,0]
  v_pk_fma_f32 v[252:253], v[252:253], s[62:63], s[62:63] op_sel_hi:[1,0,0]
  v_pk_fma_f32 v[254:255], v[254:255], s[62:63], s[62:63] op_sel_hi:[1,0,0]
  v_pk_add_f32 v[24:25], v[160:161], v[162:163]
  v_pk_mul_f32 v[26:27], v[160:161], v[160:161]
  v_pk_fma_f32 v[26:27], v[162:163], v[162:163], v[26:27]
  v_pk_add_f32 v[24:25], v[24:25], v[164:165]
  v_pk_fma_f32 v[26:27], v[164:165], v[164:165], v[26:27]
  v_pk_add_f32 v[24:25], v[24:25], v[166:167]
  v_pk_fma_f32 v[26:27], v[166:167], v[166:167], v[26:27]
  v_pk_add_f32 v[24:25], v[24:25], v[168:169]
  v_pk_fma_f32 v[26:27], v[168:169], v[168:169], v[26:27]
  v_pk_add_f32 v[24:25], v[24:25], v[170:171]
  v_pk_fma_f32 v[26:27], v[170:171], v[170:171], v[26:27]
  v_pk_add_f32 v[24:25], v[24:25], v[172:173]
  v_pk_fma_f32 v[26:27], v[172:173], v[172:173], v[26:27]
  v_pk_add_f32 v[24:25], v[24:25], v[174:175]
  v_pk_fma_f32 v[26:27], v[174:175], v[174:175], v[26:27]
  v_add_f32 v24, v24, v25
  v_add_f32 v26, v26, v27
  s_nop 1
  v_permlane32_swap_b32 v24, v26
  v_add_f32 v24, v24, v26
  ds_write_b32 v19, v24 offset:0
  v_rcp_f32 v240, v240
  v_rcp_f32 v241, v241
  v_rcp_f32 v242, v242
  v_rcp_f32 v243, v243
  v_rcp_f32 v244, v244
  v_rcp_f32 v245, v245
  v_rcp_f32 v246, v246
  v_rcp_f32 v247, v247
  v_rcp_f32 v248, v248
  v_rcp_f32 v249, v249
  v_rcp_f32 v250, v250
  v_rcp_f32 v251, v251
  v_rcp_f32 v252, v252
  v_rcp_f32 v253, v253
  v_rcp_f32 v254, v254
  v_rcp_f32 v255, v255
  v_pk_mul_f32 v[224:225], v[224:225], v[240:241]
  v_pk_mul_f32 v[226:227], v[226:227], v[242:243]
  v_pk_mul_f32 v[228:229], v[228:229], v[244:245]
  v_pk_mul_f32 v[230:231], v[230:231], v[246:247]
  v_pk_mul_f32 v[232:233], v[232:233], v[248:249]
  v_pk_mul_f32 v[234:235], v[234:235], v[250:251]
  v_pk_mul_f32 v[236:237], v[236:237], v[252:253]
  v_pk_mul_f32 v[238:239], v[238:239], v[254:255]
  v_cvt_pk_bf16_f32 v76, v224, v225
  v_cvt_pk_bf16_f32 v77, v226, v227
  v_cvt_pk_bf16_f32 v78, v228, v229
  v_cvt_pk_bf16_f32 v79, v230, v231
  ds_write_b128 v16, v[76:79] offset:4928
  v_cvt_pk_bf16_f32 v80, v232, v233
  v_cvt_pk_bf16_f32 v81, v234, v235
  v_cvt_pk_bf16_f32 v82, v236, v237
  v_cvt_pk_bf16_f32 v83, v238, v239
  ds_write_b128 v16, v[80:83] offset:4960
  s_add_u32 m0, s56, 16384
  s_nop 0
  buffer_load_dwordx4 v65, s[28:31], 0 offen offset:1024 nt lds
  s_add_u32 m0, s56, 24576
  s_nop 0
  buffer_load_dwordx4 v64, s[24:27], 0 offen nt lds
  s_add_u32 m0, s56, 24576
  s_nop 0
  buffer_load_dwordx4 v65, s[24:27], 0 offen offset:1024 nt lds
  s_waitcnt vmcnt(10) lgkmcnt(0)
  s_barrier
  ds_read_b128 v[68:71], v20 offset:0
  ds_read_b128 v[72:75], v20 offset:512
  ds_read_b128 v[44:47], v8 offset:0
  ds_read_b128 v[48:51], v9 offset:0
  s_waitcnt vmcnt(7)
  ds_read_b64_tr_b16 a[36:37], v5 offset:9216
  ds_read_b64_tr_b16 a[38:39], v5 offset:9472
  ds_read_b64_tr_b16 a[40:41], v5 offset:10240
  ds_read_b64_tr_b16 a[42:43], v5 offset:10496
  ds_read_b64_tr_b16 a[44:45], v5 offset:11264
  ds_read_b64_tr_b16 a[46:47], v5 offset:11520
  s_waitcnt vmcnt(4)
  ds_read_b64_tr_b16 a[48:49], v5 offset:12288
  ds_read_b64_tr_b16 a[50:51], v5 offset:12544
  ds_read_b64_tr_b16 a[52:53], v5 offset:13312
  ds_read_b64_tr_b16 a[54:55], v5 offset:13568
  ds_read_b64_tr_b16 a[56:57], v5 offset:14336
  ds_read_b64_tr_b16 a[58:59], v5 offset:14592
  v_mfma_f32_32x32x16_bf16 v[144:159], a[0:3], v[32:35], v[144:159]
  s_add_u32 m0, s54, 0
  s_mov_b32 s73, 53248
  buffer_load_dwordx4 v4, s[44:47], s73 offen lds
  v_mfma_f32_32x32x16_bf16 v[128:143], a[4:7], v[32:35], v[128:143]
  ds_read_b128 v[52:55], v10 offset:0
  buffer_load_dwordx4 v92, s[44:47], s73 offen offset:1024 lds
  s_waitcnt lgkmcnt(15)
  v_add_f32 v68, v68, v69
  v_add_f32 v72, v72, v73
  v_add_f32 v70, v70, v71
  v_add_f32 v74, v74, v75
  v_add_f32 v68, v68, v70
  v_add_f32 v72, v72, v74
  v_mfma_f32_32x32x16_bf16 v[144:159], a[12:15], v[36:39], v[144:159]
  v_mul_f32 v29, s63, v68
  v_mul_f32 v31, s63, v72
  v_fma_f32 v31, -v29, v29, v31
  v_max_f32 v31, 0, v31
  v_add_f32 v31, s64, v31
  v_rsq_f32 v31, v31
  s_nop 0
  v_mul_f32 v28, s62, v31
  v_mul_f32 v30, -v29, v28
  buffer_load_dwordx4 v93, s[44:47], s73 offen offset:2048 lds
  v_pk_fma_f32 v[224:225], v[160:161], v[28:29], v[30:31] op_sel_hi:[1,0,0]
  v_pk_fma_f32 v[226:227], v[162:163], v[28:29], v[30:31] op_sel_hi:[1,0,0]
  v_pk_fma_f32 v[228:229], v[164:165], v[28:29], v[30:31] op_sel_hi:[1,0,0]
  v_pk_fma_f32 v[230:231], v[166:167], v[28:29], v[30:31] op_sel_hi:[1,0,0]
  v_pk_fma_f32 v[232:233], v[168:169], v[28:29], v[30:31] op_sel_hi:[1,0,0]
  v_pk_fma_f32 v[234:235], v[170:171], v[28:29], v[30:31] op_sel_hi:[1,0,0]
  v_pk_fma_f32 v[236:237], v[172:173], v[28:29], v[30:31] op_sel_hi:[1,0,0]
  v_pk_fma_f32 v[238:239], v[174:175], v[28:29], v[30:31] op_sel_hi:[1,0,0]
  v_mfma_f32_32x32x16_bf16 v[128:143], a[16:19], v[36:39], v[128:143]
  ds_read_b128 v[32:35], v11 offset:0
  v_exp_f32 v240, -v224
  v_exp_f32 v241, -v225
  v_exp_f32 v242, -v226
  v_mfma_f32_32x32x16_bf16 v[144:159], a[24:27], v[40:43], v[144:159]
  v_exp_f32 v243, -v227
  v_exp_f32 v244, -v228
  v_exp_f32 v245, -v229
  v_mfma_f32_32x32x16_bf16 v[128:143], a[28:31], v[40:43], v[128:143]
  ds_read_b128 v[36:39], v12 offset:0
  v_exp_f32 v246, -v230
  v_exp_f32 v247, -v231
  v_exp_f32 v248, -v232
  s_waitcnt lgkmcnt(15)
  v_mfma_f32_32x32x16_bf16 v[176:191], v[192:195], v[44:47], 0
  ds_read_b128 v[40:43], v13 offset:0
  v_exp_f32 v249, -v233
  v_exp_f32 v250, -v234
  v_exp_f32 v251, -v235
  v_mfma_f32_32x32x16_bf16 v[176:191], v[196:199], v[48:51], v[176:191]
  ds_read_b128 v[44:47], v14 offset:0
  v_exp_f32 v252, -v236
  v_exp_f32 v253, -v237
  v_exp_f32 v254, -v238
  v_exp_f32 v255, -v239
  s_waitcnt lgkmcnt(3)
  v_mfma_f32_32x32x16_bf16 v[176:191], v[200:203], v[52:55], v[176:191]
  ds_read_b128 v[48:51], v15 offset:0
  v_mfma_f32_32x32x16_bf16 v[176:191], v[204:207], v[32:35], v[176:191]
  ds_read_b128 v[52:55], v21 offset:8192
  s_waitcnt lgkmcnt(3)
  v_mfma_f32_32x32x16_bf16 v[176:191], v[208:211], v[36:39], v[176:191]
  ds_read_b128 v[32:35], v22 offset:8192
  v_mfma_f32_32x32x16_bf16 v[176:191], v[212:215], v[40:43], v[176:191]
  ds_read_b128 v[36:39], v7 offset:5296
  s_waitcnt lgkmcnt(3)
  v_mfma_f32_32x32x16_bf16 v[176:191], v[216:219], v[44:47], v[176:191]
  ds_read_b128 v[40:43], v7 offset:5328
  v_mfma_f32_32x32x16_bf16 v[176:191], v[220:223], v[48:51], v[176:191]
  ds_read_b128 v[44:47], v7 offset:10128
  s_waitcnt lgkmcnt(3)
  v_mfma_f32_32x32x16_bf16 v[176:191], v[56:59], v[52:55], v[176:191]
  ds_read_b128 v[48:51], v7 offset:10160
  v_mfma_f32_32x32x16_bf16 v[176:191], v[60:63], v[32:35], v[176:191]
  ds_read_b128 v[52:55], v7 offset:10192
  s_waitcnt lgkmcnt(3)
  v_mfma_f32_32x32x16_bf16 v[144:159], a[36:39], v[36:39], v[144:159]
  s_add_u32 m0, s56, 32768
  s_nop 0
  buffer_load_dwordx4 v66, s[28:31], 0 offen nt lds
  s_add_u32 m0, s56, 32768
  s_nop 0
  buffer_load_dwordx4 v67, s[28:31], 0 offen offset:1024 nt lds
  v_pk_fma_f32 v[240:241], v[240:241], s[62:63], s[62:63] op_sel_hi:[1,0,0]
  v_pk_fma_f32 v[242:243], v[242:243], s[62:63], s[62:63] op_sel_hi:[1,0,0]
  v_pk_fma_f32 v[244:245], v[244:245], s[62:63], s[62:63] op_sel_hi:[1,0,0]
  v_pk_fma_f32 v[246:247], v[246:247], s[62:63], s[62:63] op_sel_hi:[1,0,0]
  v_pk_fma_f32 v[248:249], v[248:249], s[62:63], s[62:63] op_sel_hi:[1,0,0]
  v_pk_fma_f32 v[250:251], v[250:251], s[62:63], s[62:63] op_sel_hi:[1,0,0]
  v_pk_fma_f32 v[252:253], v[252:253], s[62:63], s[62:63] op_sel_hi:[1,0,0]
  v_pk_fma_f32 v[254:255], v[254:255], s[62:63], s[62:63] op_sel_hi:[1,0,0]
  v_pk_add_f32 v[24:25], v[176:177], v[178:179]
  v_pk_mul_f32 v[26:27], v[176:177], v[176:177]
  v_pk_fma_f32 v[26:27], v[178:179], v[178:179], v[26:27]
  v_pk_add_f32 v[24:25], v[24:25], v[180:181]
  v_pk_fma_f32 v[26:27], v[180:181], v[180:181], v[26:27]
  v_pk_add_f32 v[24:25], v[24:25], v[182:183]
  v_pk_fma_f32 v[26:27], v[182:183], v[182:183], v[26:27]
  v_pk_add_f32 v[24:25], v[24:25], v[184:185]
  v_pk_fma_f32 v[26:27], v[184:185], v[184:185], v[26:27]
  v_pk_add_f32 v[24:25], v[24:25], v[186:187]
  v_pk_fma_f32 v[26:27], v[186:187], v[186:187], v[26:27]
  v_pk_add_f32 v[24:25], v[24:25], v[188:189]
  v_pk_fma_f32 v[26:27], v[188:189], v[188:189], v[26:27]
  v_pk_add_f32 v[24:25], v[24:25], v[190:191]
  v_pk_fma_f32 v[26:27], v[190:191], v[190:191], v[26:27]
  v_mfma_f32_32x32x16_bf16 v[128:143], a[40:43], v[36:39], v[128:143]
  v_add_f32 v24, v24, v25
  v_add_f32 v26, v26, v27
  s_nop 1
  v_permlane32_swap_b32 v24, v26
  v_add_f32 v24, v24, v26
  ds_write_b32 v19, v24 offset:1024
  v_mfma_f32_32x32x16_bf16 v[144:159], a[48:51], v[40:43], v[144:159]
  v_rcp_f32 v240, v240
  v_rcp_f32 v241, v241
  v_rcp_f32 v242, v242
  v_mfma_f32_32x32x16_bf16 v[128:143], a[52:55], v[40:43], v[128:143]
  v_rcp_f32 v243, v243
  v_rcp_f32 v244, v244
  v_rcp_f32 v245, v245
  v_rcp_f32 v246, v246
  v_rcp_f32 v247, v247
  v_rcp_f32 v248, v248
  v_rcp_f32 v249, v249
  v_rcp_f32 v250, v250
  v_rcp_f32 v251, v251
  v_rcp_f32 v252, v252
  v_rcp_f32 v253, v253
  v_rcp_f32 v254, v254
  v_rcp_f32 v255, v255
  v_pk_mul_f32 v[224:225], v[224:225], v[240:241]
  v_pk_mul_f32 v[226:227], v[226:227], v[242:243]
  v_pk_mul_f32 v[228:229], v[228:229], v[244:245]
  v_pk_mul_f32 v[230:231], v[230:231], v[246:247]
  v_pk_mul_f32 v[232:233], v[232:233], v[248:249]
  v_pk_mul_f32 v[234:235], v[234:235], v[250:251]
  v_pk_mul_f32 v[236:237], v[236:237], v[252:253]
  v_pk_mul_f32 v[238:239], v[238:239], v[254:255]
  v_cvt_pk_bf16_f32 v76, v224, v225
  v_cvt_pk_bf16_f32 v77, v226, v227
  v_cvt_pk_bf16_f32 v78, v228, v229
  v_cvt_pk_bf16_f32 v79, v230, v231
  ds_write_b128 v16, v[76:79] offset:9856
  v_cvt_pk_bf16_f32 v80, v232, v233
  v_cvt_pk_bf16_f32 v81, v234, v235
  v_cvt_pk_bf16_f32 v82, v236, v237
  v_cvt_pk_bf16_f32 v83, v238, v239
  ds_write_b128 v16, v[80:83] offset:9888
  s_add_u32 m0, s56, 40960
  s_nop 0
  buffer_load_dwordx4 v66, s[24:27], 0 offen nt lds
  s_add_u32 m0, s56, 40960
  s_nop 0
  buffer_load_dwordx4 v67, s[24:27], 0 offen offset:1024 nt lds
  s_waitcnt vmcnt(7) lgkmcnt(0)
  s_barrier
  ds_read_b128 v[68:71], v20 offset:1024
  ds_read_b128 v[72:75], v20 offset:1536
  ds_read_b128 v[32:35], v8 offset:16384
  ds_read_b128 v[36:39], v9 offset:16384
  s_waitcnt vmcnt(4)
  ds_read_b64_tr_b16 a[60:61], v5 offset:0
  ds_read_b64_tr_b16 a[62:63], v5 offset:256
  ds_read_b64_tr_b16 a[64:65], v5 offset:1024
  ds_read_b64_tr_b16 a[66:67], v5 offset:1280
  ds_read_b64_tr_b16 a[68:69], v5 offset:2048
  ds_read_b64_tr_b16 a[70:71], v5 offset:2304
  v_mfma_f32_32x32x16_bf16 v[160:175], a[0:3], v[44:47], v[160:175]
  s_add_u32 m0, s54, 3072
  s_mov_b32 s73, 57344
  buffer_load_dwordx4 v4, s[44:47], s73 offen lds
  v_mfma_f32_32x32x16_bf16 v[144:159], a[4:7], v[44:47], v[144:159]
  s_waitcnt lgkmcnt(8)
  v_add_f32 v68, v68, v69
  v_add_f32 v72, v72, v73
  v_add_f32 v70, v70, v71
  v_add_f32 v74, v74, v75
  v_add_f32 v68, v68, v70
  v_add_f32 v72, v72, v74
  v_mfma_f32_32x32x16_bf16 v[128:143], a[8:11], v[44:47], v[128:143]
  ds_read_b128 v[40:43], v10 offset:16384
  v_mul_f32 v29, s63, v68
  v_mul_f32 v31, s63, v72
  v_fma_f32 v31, -v29, v29, v31
  v_max_f32 v31, 0, v31
  v_add_f32 v31, s64, v31
  v_rsq_f32 v31, v31
  s_nop 0
  v_mul_f32 v28, s62, v31
  v_mul_f32 v30, -v29, v28
  v_pk_fma_f32 v[224:225], v[176:177], v[28:29], v[30:31] op_sel_hi:[1,0,0]
  v_pk_fma_f32 v[226:227], v[178:179], v[28:29], v[30:31] op_sel_hi:[1,0,0]
  v_pk_fma_f32 v[228:229], v[180:181], v[28:29], v[30:31] op_sel_hi:[1,0,0]
  v_pk_fma_f32 v[230:231], v[182:183], v[28:29], v[30:31] op_sel_hi:[1,0,0]
  v_pk_fma_f32 v[232:233], v[184:185], v[28:29], v[30:31] op_sel_hi:[1,0,0]
  v_pk_fma_f32 v[234:235], v[186:187], v[28:29], v[30:31] op_sel_hi:[1,0,0]
  v_pk_fma_f32 v[236:237], v[188:189], v[28:29], v[30:31] op_sel_hi:[1,0,0]
  v_pk_fma_f32 v[238:239], v[190:191], v[28:29], v[30:31] op_sel_hi:[1,0,0]
  v_mfma_f32_32x32x16_bf16 v[160:175], a[12:15], v[48:51], v[160:175]
  v_exp_f32 v240, -v224
  v_exp_f32 v241, -v225
  v_exp_f32 v242, -v226
  v_mfma_f32_32x32x16_bf16 v[144:159], a[16:19], v[48:51], v[144:159]
  v_exp_f32 v243, -v227
  v_exp_f32 v244, -v228
  v_exp_f32 v245, -v229
  v_mfma_f32_32x32x16_bf16 v[128:143], a[20:23], v[48:51], v[128:143]
  ds_read_b128 v[44:47], v11 offset:16384
  v_exp_f32 v246, -v230
  v_exp_f32 v247, -v231
  v_exp_f32 v248, -v232
  v_mfma_f32_32x32x16_bf16 v[160:175], a[24:27], v[52:55], v[160:175]
  v_exp_f32 v249, -v233
  v_exp_f32 v250, -v234
  v_exp_f32 v251, -v235
  v_mfma_f32_32x32x16_bf16 v[144:159], a[28:31], v[52:55], v[144:159]
  v_exp_f32 v252, -v236
  v_exp_f32 v253, -v237
  v_exp_f32 v254, -v238
  v_exp_f32 v255, -v239
  v_mfma_f32_32x32x16_bf16 v[128:143], a[32:35], v[52:55], v[128:143]
  ds_read_b128 v[48:51], v12 offset:16384
  s_waitcnt lgkmcnt(9)
  v_mfma_f32_32x32x16_bf16 v[112:127], v[192:195], v[32:35], 0
  ds_read_b128 v[52:55], v13 offset:16384
  v_mfma_f32_32x32x16_bf16 v[112:127], v[196:199], v[36:39], v[112:127]
  ds_read_b128 v[32:35], v14 offset:16384
  s_waitcnt lgkmcnt(3)
  v_mfma_f32_32x32x16_bf16 v[112:127], v[200:203], v[40:43], v[112:127]
  ds_read_b128 v[36:39], v15 offset:16384
  v_mfma_f32_32x32x16_bf16 v[112:127], v[204:207], v[44:47], v[112:127]
  ds_read_b128 v[40:43], v21 offset:24576
  s_waitcnt lgkmcnt(3)
  v_mfma_f32_32x32x16_bf16 v[112:127], v[208:211], v[48:51], v[112:127]
  ds_read_b128 v[44:47], v22 offset:24576
  v_mfma_f32_32x32x16_bf16 v[112:127], v[212:215], v[52:55], v[112:127]
  ds_read_b128 v[48:51], v7 offset:5360
  s_waitcnt lgkmcnt(3)
  v_mfma_f32_32x32x16_bf16 v[112:127], v[216:219], v[32:35], v[112:127]
  ds_read_b128 v[52:55], v7 offset:10224
  v_mfma_f32_32x32x16_bf16 v[112:127], v[220:223], v[36:39], v[112:127]
  ds_read_b128 v[32:35], v7 offset:10256
  s_waitcnt lgkmcnt(3)
  v_mfma_f32_32x32x16_bf16 v[112:127], v[56:59], v[40:43], v[112:127]
  ds_read_b128 v[36:39], v7 offset:10288
  v_mfma_f32_32x32x16_bf16 v[112:127], v[60:63], v[44:47], v[112:127]
  ds_read_b128 v[40:43], v7 offset:15056
  buffer_load_dwordx4 v92, s[44:47], s73 offen offset:1024 lds
  v_pk_fma_f32 v[240:241], v[240:241], s[62:63], s[62:63] op_sel_hi:[1,0,0]
  v_pk_fma_f32 v[242:243], v[242:243], s[62:63], s[62:63] op_sel_hi:[1,0,0]
  v_pk_fma_f32 v[244:245], v[244:245], s[62:63], s[62:63] op_sel_hi:[1,0,0]
  v_pk_fma_f32 v[246:247], v[246:247], s[62:63], s[62:63] op_sel_hi:[1,0,0]
  v_pk_fma_f32 v[248:249], v[248:249], s[62:63], s[62:63] op_sel_hi:[1,0,0]
  v_pk_fma_f32 v[250:251], v[250:251], s[62:63], s[62:63] op_sel_hi:[1,0,0]
  v_pk_fma_f32 v[252:253], v[252:253], s[62:63], s[62:63] op_sel_hi:[1,0,0]
  v_pk_fma_f32 v[254:255], v[254:255], s[62:63], s[62:63] op_sel_hi:[1,0,0]
  s_nop 1
  v_pk_add_f32 v[24:25], v[112:113], v[114:115]
  v_pk_mul_f32 v[26:27], v[112:113], v[112:113]
  v_pk_fma_f32 v[26:27], v[114:115], v[114:115], v[26:27]
  v_pk_add_f32 v[24:25], v[24:25], v[116:117]
  v_pk_fma_f32 v[26:27], v[116:117], v[116:117], v[26:27]
  v_pk_add_f32 v[24:25], v[24:25], v[118:119]
  v_pk_fma_f32 v[26:27], v[118:119], v[118:119], v[26:27]
  v_pk_add_f32 v[24:25], v[24:25], v[120:121]
  v_pk_fma_f32 v[26:27], v[120:121], v[120:121], v[26:27]
  v_pk_add_f32 v[24:25], v[24:25], v[122:123]
  v_pk_fma_f32 v[26:27], v[122:123], v[122:123], v[26:27]
  v_pk_add_f32 v[24:25], v[24:25], v[124:125]
  v_pk_fma_f32 v[26:27], v[124:125], v[124:125], v[26:27]
  v_pk_add_f32 v[24:25], v[24:25], v[126:127]
  v_pk_fma_f32 v[26:27], v[126:127], v[126:127], v[26:27]
  s_waitcnt lgkmcnt(3)
  v_mfma_f32_32x32x16_bf16 v[144:159], a[60:63], v[48:51], v[144:159]
  v_add_f32 v24, v24, v25
  v_add_f32 v26, v26, v27
  s_nop 1
  v_permlane32_swap_b32 v24, v26
  v_add_f32 v24, v24, v26
  ds_write_b32 v19, v24 offset:0
  v_mfma_f32_32x32x16_bf16 v[128:143], a[64:67], v[48:51], v[128:143]
  ds_read_b128 v[44:47], v7 offset:15088
  v_rcp_f32 v240, v240
  v_rcp_f32 v241, v241
  v_rcp_f32 v242, v242
  v_mfma_f32_32x32x16_bf16 v[160:175], a[36:39], v[52:55], v[160:175]
  v_rcp_f32 v243, v243
  v_rcp_f32 v244, v244
  v_rcp_f32 v245, v245
  v_mfma_f32_32x32x16_bf16 v[144:159], a[40:43], v[52:55], v[144:159]
  v_rcp_f32 v246, v246
  v_rcp_f32 v247, v247
  v_rcp_f32 v248, v248
  v_mfma_f32_32x32x16_bf16 v[128:143], a[44:47], v[52:55], v[128:143]
  ds_read_b128 v[48:51], v7 offset:15120
  v_rcp_f32 v249, v249
  v_rcp_f32 v250, v250
  v_rcp_f32 v251, v251
  s_waitcnt lgkmcnt(4)
  v_mfma_f32_32x32x16_bf16 v[160:175], a[48:51], v[32:35], v[160:175]
  v_rcp_f32 v252, v252
  v_rcp_f32 v253, v253
  v_rcp_f32 v254, v254
  v_rcp_f32 v255, v255
  v_pk_mul_f32 v[224:225], v[224:225], v[240:241]
  v_pk_mul_f32 v[226:227], v[226:227], v[242:243]
  v_pk_mul_f32 v[228:229], v[228:229], v[244:245]
  v_pk_mul_f32 v[230:231], v[230:231], v[246:247]
  v_pk_mul_f32 v[232:233], v[232:233], v[248:249]
  v_pk_mul_f32 v[234:235], v[234:235], v[250:251]
  v_pk_mul_f32 v[236:237], v[236:237], v[252:253]
  v_pk_mul_f32 v[238:239], v[238:239], v[254:255]
  v_mfma_f32_32x32x16_bf16 v[144:159], a[52:55], v[32:35], v[144:159]
  v_cvt_pk_bf16_f32 v76, v224, v225
  v_cvt_pk_bf16_f32 v77, v226, v227
  v_cvt_pk_bf16_f32 v78, v228, v229
  v_cvt_pk_bf16_f32 v79, v230, v231
  ds_write_b128 v16, v[76:79] offset:14784
  v_mfma_f32_32x32x16_bf16 v[128:143], a[56:59], v[32:35], v[128:143]
  v_cvt_pk_bf16_f32 v80, v232, v233
  v_cvt_pk_bf16_f32 v81, v234, v235
  v_cvt_pk_bf16_f32 v82, v236, v237
  v_cvt_pk_bf16_f32 v83, v238, v239
  ds_write_b128 v16, v[80:83] offset:14816
  v_mfma_f32_32x32x16_bf16 v[160:175], a[60:63], v[36:39], v[160:175]
  buffer_load_dwordx4 v93, s[44:47], s73 offen offset:2048 lds
  v_mfma_f32_32x32x16_bf16 v[144:159], a[64:67], v[36:39], v[144:159]
  v_mfma_f32_32x32x16_bf16 v[128:143], a[68:71], v[36:39], v[128:143]
  s_waitcnt vmcnt(3) lgkmcnt(0)
  s_barrier
  ds_read_b128 v[68:71], v20 offset:0
  ds_read_b128 v[72:75], v20 offset:512
  ds_read_b128 v[52:55], v8 offset:32768
  ds_read_b128 v[32:35], v9 offset:32768
  s_waitcnt vmcnt(0)
  ds_read_b64_tr_b16 a[72:73], v5 offset:3072
  ds_read_b64_tr_b16 a[74:75], v5 offset:3328
  ds_read_b64_tr_b16 a[76:77], v5 offset:4096
  ds_read_b64_tr_b16 a[78:79], v5 offset:4352
  ds_read_b64_tr_b16 a[80:81], v5 offset:5120
  ds_read_b64_tr_b16 a[82:83], v5 offset:5376
  v_mfma_f32_32x32x16_bf16 v[176:191], a[0:3], v[40:43], v[176:191]
  s_add_u32 m0, s54, 6144
  s_mov_b32 s73, 61440
  buffer_load_dwordx4 v4, s[44:47], s73 offen lds
  v_mfma_f32_32x32x16_bf16 v[160:175], a[4:7], v[40:43], v[160:175]
  s_waitcnt lgkmcnt(8)
  v_add_f32 v68, v68, v69
  v_add_f32 v72, v72, v73
  v_add_f32 v70, v70, v71
  v_add_f32 v74, v74, v75
  v_add_f32 v68, v68, v70
  v_add_f32 v72, v72, v74
  v_mfma_f32_32x32x16_bf16 v[144:159], a[8:11], v[40:43], v[144:159]
  ds_read_b128 v[36:39], v10 offset:32768
  v_mul_f32 v29, s63, v68
  v_mul_f32 v31, s63, v72
  v_fma_f32 v31, -v29, v29, v31
  v_max_f32 v31, 0, v31
  v_add_f32 v31, s64, v31
  v_rsq_f32 v31, v31
  s_nop 0
  v_mul_f32 v28, s62, v31
  v_mul_f32 v30, -v29, v28
  v_pk_fma_f32 v[224:225], v[112:113], v[28:29], v[30:31] op_sel_hi:[1,0,0]
  v_pk_fma_f32 v[226:227], v[114:115], v[28:29], v[30:31] op_sel_hi:[1,0,0]
  v_pk_fma_f32 v[228:229], v[116:117], v[28:29], v[30:31] op_sel_hi:[1,0,0]
  v_pk_fma_f32 v[230:231], v[118:119], v[28:29], v[30:31] op_sel_hi:[1,0,0]
  v_pk_fma_f32 v[232:233], v[120:121], v[28:29], v[30:31] op_sel_hi:[1,0,0]
  v_pk_fma_f32 v[234:235], v[122:123], v[28:29], v[30:31] op_sel_hi:[1,0,0]
  v_pk_fma_f32 v[236:237], v[124:125], v[28:29], v[30:31] op_sel_hi:[1,0,0]
  v_pk_fma_f32 v[238:239], v[126:127], v[28:29], v[30:31] op_sel_hi:[1,0,0]
  v_mfma_f32_32x32x16_bf16 v[176:191], a[12:15], v[44:47], v[176:191]
  v_exp_f32 v240, -v224
  v_exp_f32 v241, -v225
  v_exp_f32 v242, -v226
  v_mfma_f32_32x32x16_bf16 v[160:175], a[16:19], v[44:47], v[160:175]
  v_exp_f32 v243, -v227
  v_exp_f32 v244, -v228
  v_exp_f32 v245, -v229
  v_mfma_f32_32x32x16_bf16 v[144:159], a[20:23], v[44:47], v[144:159]
  ds_read_b128 v[40:43], v11 offset:32768
  v_exp_f32 v246, -v230
  v_exp_f32 v247, -v231
  v_exp_f32 v248, -v232
  v_mfma_f32_32x32x16_bf16 v[176:191], a[24:27], v[48:51], v[176:191]
  v_exp_f32 v249, -v233
  v_exp_f32 v250, -v234
  v_exp_f32 v251, -v235
  v_mfma_f32_32x32x16_bf16 v[160:175], a[28:31], v[48:51], v[160:175]
  v_exp_f32 v252, -v236
  v_exp_f32 v253, -v237
  v_exp_f32 v254, -v238
  v_exp_f32 v255, -v239
  v_mfma_f32_32x32x16_bf16 v[144:159], a[32:35], v[48:51], v[144:159]
  ds_read_b128 v[44:47], v12 offset:32768
  s_waitcnt lgkmcnt(9)
  v_mfma_f32_32x32x16_bf16 v[96:111], v[192:195], v[52:55], 0
  ds_read_b128 v[48:51], v13 offset:32768
  v_mfma_f32_32x32x16_bf16 v[96:111], v[196:199], v[32:35], v[96:111]
  ds_read_b128 v[52:55], v14 offset:32768
  s_waitcnt lgkmcnt(3)
  v_mfma_f32_32x32x16_bf16 v[96:111], v[200:203], v[36:39], v[96:111]
  ds_read_b128 v[32:35], v15 offset:32768
  v_mfma_f32_32x32x16_bf16 v[96:111], v[204:207], v[40:43], v[96:111]
  ds_read_b128 v[36:39], v21 offset:40960
  s_waitcnt lgkmcnt(3)
  v_mfma_f32_32x32x16_bf16 v[96:111], v[208:211], v[44:47], v[96:111]
  ds_read_b128 v[40:43], v22 offset:40960
  v_mfma_f32_32x32x16_bf16 v[96:111], v[212:215], v[48:51], v[96:111]
  ds_read_b128 v[44:47], v7 offset:5392
  s_waitcnt lgkmcnt(3)
  v_mfma_f32_32x32x16_bf16 v[96:111], v[216:219], v[52:55], v[96:111]
  ds_read_b128 v[48:51], v7 offset:10320
  v_mfma_f32_32x32x16_bf16 v[96:111], v[220:223], v[32:35], v[96:111]
  ds_read_b128 v[52:55], v7 offset:15152
  s_waitcnt lgkmcnt(3)
  v_mfma_f32_32x32x16_bf16 v[96:111], v[56:59], v[36:39], v[96:111]
  ds_read_b128 v[32:35], v7 offset:15184
  v_mfma_f32_32x32x16_bf16 v[96:111], v[60:63], v[40:43], v[96:111]
  ds_read_b128 v[36:39], v7 offset:15216
  buffer_load_dwordx4 v92, s[44:47], s73 offen offset:1024 lds
  v_pk_fma_f32 v[240:241], v[240:241], s[62:63], s[62:63] op_sel_hi:[1,0,0]
  v_pk_fma_f32 v[242:243], v[242:243], s[62:63], s[62:63] op_sel_hi:[1,0,0]
  v_pk_fma_f32 v[244:245], v[244:245], s[62:63], s[62:63] op_sel_hi:[1,0,0]
  v_pk_fma_f32 v[246:247], v[246:247], s[62:63], s[62:63] op_sel_hi:[1,0,0]
  v_pk_fma_f32 v[248:249], v[248:249], s[62:63], s[62:63] op_sel_hi:[1,0,0]
  v_pk_fma_f32 v[250:251], v[250:251], s[62:63], s[62:63] op_sel_hi:[1,0,0]
  v_pk_fma_f32 v[252:253], v[252:253], s[62:63], s[62:63] op_sel_hi:[1,0,0]
  v_pk_fma_f32 v[254:255], v[254:255], s[62:63], s[62:63] op_sel_hi:[1,0,0]
  s_nop 1
  v_pk_add_f32 v[24:25], v[96:97], v[98:99]
  v_pk_mul_f32 v[26:27], v[96:97], v[96:97]
  v_pk_fma_f32 v[26:27], v[98:99], v[98:99], v[26:27]
  v_pk_add_f32 v[24:25], v[24:25], v[100:101]
  v_pk_fma_f32 v[26:27], v[100:101], v[100:101], v[26:27]
  v_pk_add_f32 v[24:25], v[24:25], v[102:103]
  v_pk_fma_f32 v[26:27], v[102:103], v[102:103], v[26:27]
  v_pk_add_f32 v[24:25], v[24:25], v[104:105]
  v_pk_fma_f32 v[26:27], v[104:105], v[104:105], v[26:27]
  v_pk_add_f32 v[24:25], v[24:25], v[106:107]
  v_pk_fma_f32 v[26:27], v[106:107], v[106:107], v[26:27]
  v_pk_add_f32 v[24:25], v[24:25], v[108:109]
  v_pk_fma_f32 v[26:27], v[108:109], v[108:109], v[26:27]
  v_pk_add_f32 v[24:25], v[24:25], v[110:111]
  v_pk_fma_f32 v[26:27], v[110:111], v[110:111], v[26:27]
  s_waitcnt lgkmcnt(3)
  v_mfma_f32_32x32x16_bf16 v[144:159], a[72:75], v[44:47], v[144:159]
  v_add_f32 v24, v24, v25
  v_add_f32 v26, v26, v27
  s_nop 1
  v_permlane32_swap_b32 v24, v26
  v_add_f32 v24, v24, v26
  ds_write_b32 v19, v24 offset:1024
  v_mfma_f32_32x32x16_bf16 v[128:143], a[76:79], v[44:47], v[128:143]
  ds_read_b128 v[40:43], v7 offset:15248
  v_rcp_f32 v240, v240
  v_rcp_f32 v241, v241
  v_rcp_f32 v242, v242
  v_mfma_f32_32x32x16_bf16 v[160:175], a[72:75], v[48:51], v[160:175]
  v_rcp_f32 v243, v243
  v_rcp_f32 v244, v244
  v_rcp_f32 v245, v245
  v_mfma_f32_32x32x16_bf16 v[144:159], a[76:79], v[48:51], v[144:159]
  v_rcp_f32 v246, v246
  v_rcp_f32 v247, v247
  v_rcp_f32 v248, v248
  v_mfma_f32_32x32x16_bf16 v[128:143], a[80:83], v[48:51], v[128:143]
  v_rcp_f32 v249, v249
  v_rcp_f32 v250, v250
  v_rcp_f32 v251, v251
  s_waitcnt lgkmcnt(3)
  v_mfma_f32_32x32x16_bf16 v[176:191], a[36:39], v[52:55], v[176:191]
  v_rcp_f32 v252, v252
  v_rcp_f32 v253, v253
  v_rcp_f32 v254, v254
  v_rcp_f32 v255, v255
  v_pk_mul_f32 v[224:225], v[224:225], v[240:241]
  v_pk_mul_f32 v[226:227], v[226:227], v[242:243]
  v_pk_mul_f32 v[228:229], v[228:229], v[244:245]
  v_pk_mul_f32 v[230:231], v[230:231], v[246:247]
  v_pk_mul_f32 v[232:233], v[232:233], v[248:249]
  v_pk_mul_f32 v[234:235], v[234:235], v[250:251]
  v_pk_mul_f32 v[236:237], v[236:237], v[252:253]
  v_pk_mul_f32 v[238:239], v[238:239], v[254:255]
  v_mfma_f32_32x32x16_bf16 v[160:175], a[40:43], v[52:55], v[160:175]
  v_cvt_pk_bf16_f32 v76, v224, v225
  v_cvt_pk_bf16_f32 v77, v226, v227
  v_cvt_pk_bf16_f32 v78, v228, v229
  v_cvt_pk_bf16_f32 v79, v230, v231
  ds_write_b128 v17, v[76:79] offset:0
  v_mfma_f32_32x32x16_bf16 v[144:159], a[44:47], v[52:55], v[144:159]
  v_cvt_pk_bf16_f32 v80, v232, v233
  v_cvt_pk_bf16_f32 v81, v234, v235
  v_cvt_pk_bf16_f32 v82, v236, v237
  v_cvt_pk_bf16_f32 v83, v238, v239
  ds_write_b128 v17, v[80:83] offset:32
  v_mfma_f32_32x32x16_bf16 v[176:191], a[48:51], v[32:35], v[176:191]
  buffer_load_dwordx4 v93, s[44:47], s73 offen offset:2048 lds
  v_mfma_f32_32x32x16_bf16 v[160:175], a[52:55], v[32:35], v[160:175]
  v_mfma_f32_32x32x16_bf16 v[144:159], a[56:59], v[32:35], v[144:159]
  s_waitcnt lgkmcnt(2)
  v_mfma_f32_32x32x16_bf16 v[176:191], a[60:63], v[36:39], v[176:191]
  v_mfma_f32_32x32x16_bf16 v[160:175], a[64:67], v[36:39], v[160:175]
  v_mfma_f32_32x32x16_bf16 v[144:159], a[68:71], v[36:39], v[144:159]
  v_mfma_f32_32x32x16_bf16 v[176:191], a[72:75], v[40:43], v[176:191]
  v_mfma_f32_32x32x16_bf16 v[160:175], a[76:79], v[40:43], v[160:175]
  v_mfma_f32_32x32x16_bf16 v[144:159], a[80:83], v[40:43], v[144:159]
  s_waitcnt lgkmcnt(0)
  s_barrier
  ds_read_b128 v[68:71], v20 offset:1024
  ds_read_b128 v[72:75], v20 offset:1536
  s_waitcnt vmcnt(0)
  ds_read_b64_tr_b16 a[84:85], v5 offset:6144
  ds_read_b64_tr_b16 a[86:87], v5 offset:6400
  ds_read_b64_tr_b16 a[88:89], v5 offset:7168
  ds_read_b64_tr_b16 a[90:91], v5 offset:7424
  ds_read_b64_tr_b16 a[92:93], v5 offset:8192
  ds_read_b64_tr_b16 a[94:95], v5 offset:8448
  ds_read_b128 v[44:47], v7 offset:5424
  ds_read_b128 v[48:51], v7 offset:10352
  ds_read_b128 v[52:55], v7 offset:15280
  ds_read_b128 v[32:35], v7 offset:19984
  ds_read_b128 v[36:39], v7 offset:20016
  s_waitcnt lgkmcnt(3)
  v_mfma_f32_32x32x16_bf16 v[144:159], a[84:87], v[44:47], v[144:159]
  s_add_u32 m0, s54, 9216
  s_mov_b32 s73, 0
  buffer_load_dwordx4 v4, s[44:47], s73 offen lds
  v_mfma_f32_32x32x16_bf16 v[128:143], a[88:91], v[44:47], v[128:143]
  ds_read_b128 v[40:43], v7 offset:20048
  buffer_load_dwordx4 v92, s[44:47], s73 offen offset:1024 lds
  v_add_f32 v68, v68, v69
  v_add_f32 v72, v72, v73
  v_add_f32 v70, v70, v71
  v_add_f32 v74, v74, v75
  v_add_f32 v68, v68, v70
  v_add_f32 v72, v72, v74
  v_mfma_f32_32x32x16_bf16 v[160:175], a[84:87], v[48:51], v[160:175]
  v_mul_f32 v29, s63, v68
  v_mul_f32 v31, s63, v72
  v_fma_f32 v31, -v29, v29, v31
  v_max_f32 v31, 0, v31
  v_add_f32 v31, s64, v31
  v_rsq_f32 v31, v31
  s_nop 0
  v_mul_f32 v28, s62, v31
  v_mul_f32 v30, -v29, v28
  v_mfma_f32_32x32x16_bf16 v[144:159], a[88:91], v[48:51], v[144:159]
  buffer_load_dwordx4 v93, s[44:47], s73 offen offset:2048 lds
  s_add_u32 m0, s54, 12288
  s_mov_b32 s73, 4096
  v_mfma_f32_32x32x16_bf16 v[128:143], a[92:95], v[48:51], v[128:143]
  ds_read_b128 v[44:47], v7 offset:20080
  buffer_load_dwordx4 v4, s[44:47], s73 offen lds
  buffer_load_dwordx4 v92, s[44:47], s73 offen offset:1024 lds
  s_waitcnt lgkmcnt(3)
  v_mfma_f32_32x32x16_bf16 v[176:191], a[84:87], v[52:55], v[176:191]
  buffer_load_dwordx4 v93, s[44:47], s73 offen offset:2048 lds
  s_add_u32 m0, s54, 0
  s_mov_b32 s73, 8192
  buffer_load_dwordx4 v4, s[44:47], s73 offen lds
  v_pk_fma_f32 v[224:225], v[96:97], v[28:29], v[30:31] op_sel_hi:[1,0,0]
  v_pk_fma_f32 v[226:227], v[98:99], v[28:29], v[30:31] op_sel_hi:[1,0,0]
  v_pk_fma_f32 v[228:229], v[100:101], v[28:29], v[30:31] op_sel_hi:[1,0,0]
  v_pk_fma_f32 v[230:231], v[102:103], v[28:29], v[30:31] op_sel_hi:[1,0,0]
  v_pk_fma_f32 v[232:233], v[104:105], v[28:29], v[30:31] op_sel_hi:[1,0,0]
  v_pk_fma_f32 v[234:235], v[106:107], v[28:29], v[30:31] op_sel_hi:[1,0,0]
  v_pk_fma_f32 v[236:237], v[108:109], v[28:29], v[30:31] op_sel_hi:[1,0,0]
  v_pk_fma_f32 v[238:239], v[110:111], v[28:29], v[30:31] op_sel_hi:[1,0,0]
  v_mfma_f32_32x32x16_bf16 v[160:175], a[88:91], v[52:55], v[160:175]
  v_exp_f32 v240, -v224
  v_exp_f32 v241, -v225
  v_exp_f32 v242, -v226
  v_mfma_f32_32x32x16_bf16 v[144:159], a[92:95], v[52:55], v[144:159]
  ds_read_b128 v[48:51], v7 offset:20112
  v_exp_f32 v243, -v227
  v_exp_f32 v244, -v228
  v_exp_f32 v245, -v229
  v_mfma_f32_32x32x16_bf16 v[176:191], a[4:7], v[32:35], v[176:191]
  v_exp_f32 v246, -v230
  v_exp_f32 v247, -v231
  v_exp_f32 v248, -v232
  v_mfma_f32_32x32x16_bf16 v[160:175], a[8:11], v[32:35], v[160:175]
  ds_read_b128 v[52:55], v7 offset:20144
  v_exp_f32 v249, -v233
  v_exp_f32 v250, -v234
  v_exp_f32 v251, -v235
  s_waitcnt lgkmcnt(3)
  v_mfma_f32_32x32x16_bf16 v[176:191], a[16:19], v[36:39], v[176:191]
  v_exp_f32 v252, -v236
  v_exp_f32 v253, -v237
  v_exp_f32 v254, -v238
  v_exp_f32 v255, -v239
  v_pk_fma_f32 v[240:241], v[240:241], s[62:63], s[62:63] op_sel_hi:[1,0,0]
  v_pk_fma_f32 v[242:243], v[242:243], s[62:63], s[62:63] op_sel_hi:[1,0,0]
  v_pk_fma_f32 v[244:245], v[244:245], s[62:63], s[62:63] op_sel_hi:[1,0,0]
  v_pk_fma_f32 v[246:247], v[246:247], s[62:63], s[62:63] op_sel_hi:[1,0,0]
  v_pk_fma_f32 v[248:249], v[248:249], s[62:63], s[62:63] op_sel_hi:[1,0,0]
  v_pk_fma_f32 v[250:251], v[250:251], s[62:63], s[62:63] op_sel_hi:[1,0,0]
  v_pk_fma_f32 v[252:253], v[252:253], s[62:63], s[62:63] op_sel_hi:[1,0,0]
  v_pk_fma_f32 v[254:255], v[254:255], s[62:63], s[62:63] op_sel_hi:[1,0,0]
  v_mfma_f32_32x32x16_bf16 v[160:175], a[20:23], v[36:39], v[160:175]
  ds_read_b128 v[32:35], v7 offset:20176
  v_rcp_f32 v240, v240
  v_rcp_f32 v241, v241
  v_rcp_f32 v242, v242
  v_mfma_f32_32x32x16_bf16 v[176:191], a[28:31], v[40:43], v[176:191]
  v_rcp_f32 v243, v243
  v_rcp_f32 v244, v244
  v_rcp_f32 v245, v245
  v_mfma_f32_32x32x16_bf16 v[160:175], a[32:35], v[40:43], v[160:175]
  ds_read_b128 v[36:39], v7 offset:20208
  v_rcp_f32 v246, v246
  v_rcp_f32 v247, v247
  v_rcp_f32 v248, v248
  s_waitcnt lgkmcnt(3)
  v_mfma_f32_32x32x16_bf16 v[176:191], a[40:43], v[44:47], v[176:191]
  v_rcp_f32 v249, v249
  v_rcp_f32 v250, v250
  v_rcp_f32 v251, v251
  v_mfma_f32_32x32x16_bf16 v[160:175], a[44:47], v[44:47], v[160:175]
  v_rcp_f32 v252, v252
  v_rcp_f32 v253, v253
  v_rcp_f32 v254, v254
  v_rcp_f32 v255, v255
  v_pk_mul_f32 v[224:225], v[224:225], v[240:241]
  v_pk_mul_f32 v[226:227], v[226:227], v[242:243]
  v_pk_mul_f32 v[228:229], v[228:229], v[244:245]
  v_pk_mul_f32 v[230:231], v[230:231], v[246:247]
  v_pk_mul_f32 v[232:233], v[232:233], v[248:249]
  v_pk_mul_f32 v[234:235], v[234:235], v[250:251]
  v_pk_mul_f32 v[236:237], v[236:237], v[252:253]
  v_pk_mul_f32 v[238:239], v[238:239], v[254:255]
  v_mfma_f32_32x32x16_bf16 v[176:191], a[52:55], v[48:51], v[176:191]
  v_cvt_pk_bf16_f32 v76, v224, v225
  v_cvt_pk_bf16_f32 v77, v226, v227
  v_cvt_pk_bf16_f32 v78, v228, v229
  v_cvt_pk_bf16_f32 v79, v230, v231
  ds_write_b128 v18, v[76:79] offset:0
  v_mfma_f32_32x32x16_bf16 v[160:175], a[56:59], v[48:51], v[160:175]
  v_cvt_pk_bf16_f32 v80, v232, v233
  v_cvt_pk_bf16_f32 v81, v234, v235
  v_cvt_pk_bf16_f32 v82, v236, v237
  v_cvt_pk_bf16_f32 v83, v238, v239
  ds_write_b128 v18, v[80:83] offset:32
  s_waitcnt lgkmcnt(3)
  v_mfma_f32_32x32x16_bf16 v[176:191], a[64:67], v[52:55], v[176:191]
  buffer_load_dwordx4 v92, s[44:47], s73 offen offset:1024 lds
  buffer_load_dwordx4 v93, s[44:47], s73 offen offset:2048 lds
  v_mfma_f32_32x32x16_bf16 v[160:175], a[68:71], v[52:55], v[160:175]
  s_add_u32 m0, s54, 3072
  s_mov_b32 s73, 12288
  buffer_load_dwordx4 v4, s[44:47], s73 offen lds
  v_mfma_f32_32x32x16_bf16 v[176:191], a[76:79], v[32:35], v[176:191]
  buffer_load_dwordx4 v92, s[44:47], s73 offen offset:1024 lds
  buffer_load_dwordx4 v93, s[44:47], s73 offen offset:2048 lds
  v_mfma_f32_32x32x16_bf16 v[160:175], a[80:83], v[32:35], v[160:175]
  s_add_u32 m0, s54, 6144
  s_mov_b32 s73, 16384
  buffer_load_dwordx4 v4, s[44:47], s73 offen lds
  s_waitcnt lgkmcnt(2)
  v_mfma_f32_32x32x16_bf16 v[176:191], a[88:91], v[36:39], v[176:191]
  buffer_load_dwordx4 v92, s[44:47], s73 offen offset:1024 lds
  buffer_load_dwordx4 v93, s[44:47], s73 offen offset:2048 lds
  v_mfma_f32_32x32x16_bf16 v[160:175], a[92:95], v[36:39], v[160:175]
  s_waitcnt lgkmcnt(0)
  s_barrier
  ds_read_b128 v[40:43], v7 offset:272
  ds_read_b128 v[44:47], v7 offset:304
  ds_read_b128 v[48:51], v7 offset:336
  ds_read_b128 v[52:55], v7 offset:368
  ds_read_b128 v[32:35], v7 offset:400
  s_waitcnt lgkmcnt(3)
  v_mfma_f32_32x32x16_bf16 v[128:143], a[0:3], v[40:43], v[128:143]
  ds_read_b128 v[36:39], v7 offset:432
  v_mfma_f32_32x32x16_bf16 v[128:143], a[12:15], v[44:47], v[128:143]
  ds_read_b128 v[40:43], v7 offset:464
  s_waitcnt lgkmcnt(3)
  v_mfma_f32_32x32x16_bf16 v[128:143], a[24:27], v[48:51], v[128:143]
  ds_read_b128 v[44:47], v7 offset:496
  v_mfma_f32_32x32x16_bf16 v[128:143], a[36:39], v[52:55], v[128:143]
  ds_read_b128 v[48:51], v7 offset:24912
  s_waitcnt lgkmcnt(3)
  v_mfma_f32_32x32x16_bf16 v[128:143], a[48:51], v[32:35], v[128:143]
  ds_read_b128 v[52:55], v7 offset:24944
  s_waitcnt vmcnt(12)
  ds_read_b64_tr_b16 a[96:97], v5 offset:9216
  ds_read_b64_tr_b16 a[98:99], v5 offset:9472
  v_mfma_f32_32x32x16_bf16 v[128:143], a[60:63], v[36:39], v[128:143]
  ds_read_b128 v[32:35], v7 offset:4928
  ds_read_b64_tr_b16 a[100:101], v5 offset:10240
  ds_read_b64_tr_b16 a[102:103], v5 offset:10496
  s_waitcnt lgkmcnt(7)
  v_mfma_f32_32x32x16_bf16 v[128:143], a[72:75], v[40:43], v[128:143]
  ds_read_b128 v[36:39], v7 offset:9856
  ds_read_b64_tr_b16 a[104:105], v5 offset:11264
  ds_read_b64_tr_b16 a[106:107], v5 offset:11520
  v_mfma_f32_32x32x16_bf16 v[128:143], a[84:87], v[44:47], v[128:143]
  ds_read_b128 v[40:43], v7 offset:0
  s_waitcnt lgkmcnt(9)
  v_mfma_f32_32x32x16_bf16 v[176:191], a[8:11], v[48:51], v[176:191]
  ds_read_b128 v[44:47], v7 offset:24976
  v_mfma_f32_32x32x16_bf16 v[176:191], a[20:23], v[52:55], v[176:191]
  ds_read_b128 v[48:51], v7 offset:4960
  s_waitcnt lgkmcnt(5)
  v_mfma_f32_32x32x16_bf16 v[144:159], a[96:99], v[32:35], v[144:159]
  s_waitcnt vmcnt(9)
  ds_read_b64_tr_b16 a[108:109], v5 offset:12288
  ds_read_b64_tr_b16 a[110:111], v5 offset:12544
  ds_read_b64_tr_b16 a[112:113], v5 offset:13312
  ds_read_b64_tr_b16 a[114:115], v5 offset:13568
  v_mfma_f32_32x32x16_bf16 v[128:143], a[100:103], v[32:35], v[128:143]
  ds_read_b128 v[52:55], v7 offset:9888
  ds_read_b64_tr_b16 a[116:117], v5 offset:14336
  ds_read_b64_tr_b16 a[118:119], v5 offset:14592
  s_waitcnt lgkmcnt(10)
  v_mfma_f32_32x32x16_bf16 v[160:175], a[96:99], v[36:39], v[160:175]
  s_add_u32 m0, s54, 9216
  s_mov_b32 s73, 20480
  buffer_load_dwordx4 v4, s[44:47], s73 offen lds
  v_mfma_f32_32x32x16_bf16 v[144:159], a[100:103], v[36:39], v[144:159]
  buffer_load_dwordx4 v92, s[44:47], s73 offen offset:1024 lds
  v_mfma_f32_32x32x16_bf16 v[128:143], a[104:107], v[36:39], v[128:143]
  ds_read_b128 v[32:35], v7 offset:32
  buffer_load_dwordx4 v93, s[44:47], s73 offen offset:2048 lds
  s_waitcnt lgkmcnt(9)
  v_mfma_f32_32x32x16_bf16 v[128:143], a[96:99], v[40:43], v[128:143]
  ds_read_b128 v[36:39], v7 offset:4992
  v_mfma_f32_32x32x16_bf16 v[176:191], a[32:35], v[44:47], v[176:191]
  ds_read_b128 v[40:43], v7 offset:9920
  s_waitcnt vmcnt(9)
  ds_read_b64_tr_b16 a[120:121], v5 offset:0
  ds_read_b64_tr_b16 a[122:123], v5 offset:256
  s_waitcnt lgkmcnt(7)
  v_mfma_f32_32x32x16_bf16 v[144:159], a[108:111], v[48:51], v[144:159]
  ds_read_b64_tr_b16 a[124:125], v5 offset:1024
  ds_read_b64_tr_b16 a[126:127], v5 offset:1280
  ds_read_b64_tr_b16 a[128:129], v5 offset:2048
  ds_read_b64_tr_b16 a[130:131], v5 offset:2304
  v_mfma_f32_32x32x16_bf16 v[128:143], a[112:115], v[48:51], v[128:143]
  ds_read_b128 v[44:47], v7 offset:64
  s_waitcnt lgkmcnt(10)
  s_add_u32 m0, s54, 12288
  s_mov_b32 s73, 24576
  v_mfma_f32_32x32x16_bf16 v[160:175], a[108:111], v[52:55], v[160:175]
  buffer_load_dwordx4 v4, s[44:47], s73 offen lds
  buffer_load_dwordx4 v92, s[44:47], s73 offen offset:1024 lds
  v_mfma_f32_32x32x16_bf16 v[144:159], a[112:115], v[52:55], v[144:159]
  buffer_load_dwordx4 v93, s[44:47], s73 offen offset:2048 lds
  v_mfma_f32_32x32x16_bf16 v[128:143], a[116:119], v[52:55], v[128:143]
  ds_read_b128 v[48:51], v7 offset:5024
  s_waitcnt lgkmcnt(9)
  v_mfma_f32_32x32x16_bf16 v[128:143], a[108:111], v[32:35], v[128:143]
  ds_read_b128 v[52:55], v7 offset:9952
  s_waitcnt lgkmcnt(5)
  v_mfma_f32_32x32x16_bf16 v[144:159], a[120:123], v[36:39], v[144:159]
  s_waitcnt vmcnt(9)
  ds_read_b64_tr_b16 a[132:133], v5 offset:3072
  ds_read_b64_tr_b16 a[134:135], v5 offset:3328
  ds_read_b64_tr_b16 a[136:137], v5 offset:4096
  ds_read_b64_tr_b16 a[138:139], v5 offset:4352
  v_mfma_f32_32x32x16_bf16 v[128:143], a[124:127], v[36:39], v[128:143]
  ds_read_b128 v[32:35], v7 offset:96
  ds_read_b64_tr_b16 a[140:141], v5 offset:5120
  ds_read_b64_tr_b16 a[142:143], v5 offset:5376
  s_waitcnt lgkmcnt(10)
  v_mfma_f32_32x32x16_bf16 v[160:175], a[120:123], v[40:43], v[160:175]
  s_add_u32 m0, s54, 0
  s_mov_b32 s73, 28672
  buffer_load_dwordx4 v4, s[44:47], s73 offen lds
  v_mfma_f32_32x32x16_bf16 v[144:159], a[124:127], v[40:43], v[144:159]
  buffer_load_dwordx4 v92, s[44:47], s73 offen offset:1024 lds
  v_mfma_f32_32x32x16_bf16 v[128:143], a[128:131], v[40:43], v[128:143]
  ds_read_b128 v[36:39], v7 offset:5056
  buffer_load_dwordx4 v93, s[44:47], s73 offen offset:2048 lds
  s_waitcnt lgkmcnt(9)
  v_mfma_f32_32x32x16_bf16 v[128:143], a[120:123], v[44:47], v[128:143]
  ds_read_b128 v[40:43], v7 offset:9984
  s_waitcnt lgkmcnt(5)
  v_mfma_f32_32x32x16_bf16 v[144:159], a[132:135], v[48:51], v[144:159]
  s_waitcnt vmcnt(9)
  ds_read_b64_tr_b16 a[144:145], v5 offset:6144
  ds_read_b64_tr_b16 a[146:147], v5 offset:6400
  ds_read_b64_tr_b16 a[148:149], v5 offset:7168
  ds_read_b64_tr_b16 a[150:151], v5 offset:7424
  v_mfma_f32_32x32x16_bf16 v[128:143], a[136:139], v[48:51], v[128:143]
  ds_read_b128 v[44:47], v7 offset:128
  ds_read_b64_tr_b16 a[152:153], v5 offset:8192
  ds_read_b64_tr_b16 a[154:155], v5 offset:8448
  s_waitcnt lgkmcnt(9)
  v_mfma_f32_32x32x16_bf16 v[160:175], a[132:135], v[52:55], v[160:175]
  s_add_u32 m0, s54, 3072
  s_mov_b32 s73, 65536
  buffer_load_dwordx4 v4, s[44:47], s73 offen lds
  v_mfma_f32_32x32x16_bf16 v[144:159], a[136:139], v[52:55], v[144:159]
  buffer_load_dwordx4 v92, s[44:47], s73 offen offset:1024 lds
  v_mfma_f32_32x32x16_bf16 v[128:143], a[140:143], v[52:55], v[128:143]
  ds_read_b128 v[48:51], v7 offset:25008
  buffer_load_dwordx4 v93, s[44:47], s73 offen offset:2048 lds
  v_mfma_f32_32x32x16_bf16 v[128:143], a[132:135], v[32:35], v[128:143]
  ds_read_b128 v[52:55], v7 offset:5088
  s_waitcnt lgkmcnt(5)
  v_mfma_f32_32x32x16_bf16 v[144:159], a[144:147], v[36:39], v[144:159]
  s_waitcnt vmcnt(9)
  ds_read_b64_tr_b16 a[156:157], v5 offset:9216
  ds_read_b64_tr_b16 a[158:159], v5 offset:9472
  ds_read_b64_tr_b16 a[160:161], v5 offset:10240
  ds_read_b64_tr_b16 a[162:163], v5 offset:10496
  v_mfma_f32_32x32x16_bf16 v[128:143], a[148:151], v[36:39], v[128:143]
  ds_read_b128 v[32:35], v7 offset:10016
  ds_read_b64_tr_b16 a[164:165], v5 offset:11264
  ds_read_b64_tr_b16 a[166:167], v5 offset:11520
  s_waitcnt lgkmcnt(9)
  v_mfma_f32_32x32x16_bf16 v[160:175], a[144:147], v[40:43], v[160:175]
  s_add_u32 m0, s54, 6144
  s_mov_b32 s73, 69632
  buffer_load_dwordx4 v4, s[44:47], s73 offen lds
  v_mfma_f32_32x32x16_bf16 v[144:159], a[148:151], v[40:43], v[144:159]
  buffer_load_dwordx4 v92, s[44:47], s73 offen offset:1024 lds
  v_mfma_f32_32x32x16_bf16 v[128:143], a[152:155], v[40:43], v[128:143]
  ds_read_b128 v[36:39], v7 offset:160
  buffer_load_dwordx4 v93, s[44:47], s73 offen offset:2048 lds
  v_mfma_f32_32x32x16_bf16 v[128:143], a[144:147], v[44:47], v[128:143]
  ds_read_b128 v[40:43], v7 offset:5120
  s_waitcnt lgkmcnt(9)
  v_mfma_f32_32x32x16_bf16 v[176:191], a[44:47], v[48:51], v[176:191]
  ds_read_b128 v[44:47], v7 offset:10048
  s_waitcnt vmcnt(9)
  ds_read_b64_tr_b16 a[168:169], v5 offset:12288
  ds_read_b64_tr_b16 a[170:171], v5 offset:12544
  s_waitcnt lgkmcnt(8)
  v_mfma_f32_32x32x16_bf16 v[144:159], a[156:159], v[52:55], v[144:159]
  ds_read_b64_tr_b16 a[172:173], v5 offset:13312
  ds_read_b64_tr_b16 a[174:175], v5 offset:13568
  ds_read_b64_tr_b16 a[176:177], v5 offset:14336
  ds_read_b64_tr_b16 a[178:179], v5 offset:14592
  v_mfma_f32_32x32x16_bf16 v[128:143], a[160:163], v[52:55], v[128:143]
  ds_read_b128 v[48:51], v7 offset:192
  s_waitcnt lgkmcnt(10)
  s_add_u32 m0, s54, 9216
  s_mov_b32 s73, 73728
  v_mfma_f32_32x32x16_bf16 v[160:175], a[156:159], v[32:35], v[160:175]
  buffer_load_dwordx4 v4, s[44:47], s73 offen lds
  buffer_load_dwordx4 v92, s[44:47], s73 offen offset:1024 lds
  v_mfma_f32_32x32x16_bf16 v[144:159], a[160:163], v[32:35], v[144:159]
  buffer_load_dwordx4 v93, s[44:47], s73 offen offset:2048 lds
  v_mfma_f32_32x32x16_bf16 v[128:143], a[164:167], v[32:35], v[128:143]
  ds_read_b128 v[52:55], v7 offset:5152
  s_waitcnt lgkmcnt(9)
  v_mfma_f32_32x32x16_bf16 v[128:143], a[156:159], v[36:39], v[128:143]
  ds_read_b128 v[32:35], v7 offset:10080
  s_waitcnt lgkmcnt(5)
  v_mfma_f32_32x32x16_bf16 v[144:159], a[168:171], v[40:43], v[144:159]
  s_waitcnt vmcnt(9)
  ds_read_b64_tr_b16 a[180:181], v5 offset:0
  ds_read_b64_tr_b16 a[182:183], v5 offset:256
  ds_read_b64_tr_b16 a[184:185], v5 offset:1024
  ds_read_b64_tr_b16 a[186:187], v5 offset:1280
  v_mfma_f32_32x32x16_bf16 v[128:143], a[172:175], v[40:43], v[128:143]
  ds_read_b128 v[36:39], v7 offset:224
  ds_read_b64_tr_b16 a[188:189], v5 offset:2048
  ds_read_b64_tr_b16 a[190:191], v5 offset:2304
  s_waitcnt lgkmcnt(10)
  v_mfma_f32_32x32x16_bf16 v[160:175], a[168:171], v[44:47], v[160:175]
  s_add_u32 m0, s54, 12288
  s_mov_b32 s73, 77824
  buffer_load_dwordx4 v4, s[44:47], s73 offen lds
  v_mfma_f32_32x32x16_bf16 v[144:159], a[172:175], v[44:47], v[144:159]
  buffer_load_dwordx4 v92, s[44:47], s73 offen offset:1024 lds
  v_mfma_f32_32x32x16_bf16 v[128:143], a[176:179], v[44:47], v[128:143]
  ds_read_b128 v[40:43], v7 offset:5472
  buffer_load_dwordx4 v93, s[44:47], s73 offen offset:2048 lds
  s_waitcnt lgkmcnt(9)
  v_mfma_f32_32x32x16_bf16 v[128:143], a[168:171], v[48:51], v[128:143]
  ds_read_b128 v[44:47], v7 offset:10400
  s_waitcnt lgkmcnt(5)
  v_mfma_f32_32x32x16_bf16 v[144:159], a[180:183], v[52:55], v[144:159]
  s_waitcnt vmcnt(9)
  ds_read_b64_tr_b16 a[192:193], v5 offset:3072
  ds_read_b64_tr_b16 a[194:195], v5 offset:3328
  ds_read_b64_tr_b16 a[196:197], v5 offset:4096
  ds_read_b64_tr_b16 a[198:199], v5 offset:4352
  v_mfma_f32_32x32x16_bf16 v[128:143], a[184:187], v[52:55], v[128:143]
  ds_read_b128 v[48:51], v7 offset:544
  ds_read_b64_tr_b16 a[200:201], v5 offset:5120
  ds_read_b64_tr_b16 a[202:203], v5 offset:5376
  s_waitcnt lgkmcnt(9)
  v_mfma_f32_32x32x16_bf16 v[160:175], a[180:183], v[32:35], v[160:175]
  s_add_u32 m0, s54, 0
  s_mov_b32 s73, 81920
  buffer_load_dwordx4 v4, s[44:47], s73 offen lds
  v_mfma_f32_32x32x16_bf16 v[144:159], a[184:187], v[32:35], v[144:159]
  buffer_load_dwordx4 v92, s[44:47], s73 offen offset:1024 lds
  v_mfma_f32_32x32x16_bf16 v[128:143], a[188:191], v[32:35], v[128:143]
  ds_read_b128 v[52:55], v7 offset:25040
  buffer_load_dwordx4 v93, s[44:47], s73 offen offset:2048 lds
  v_mfma_f32_32x32x16_bf16 v[128:143], a[180:183], v[36:39], v[128:143]
  ds_read_b128 v[32:35], v7 offset:5504
  s_waitcnt lgkmcnt(5)
  v_mfma_f32_32x32x16_bf16 v[144:159], a[192:195], v[40:43], v[144:159]
  s_waitcnt vmcnt(9)
  ds_read_b64_tr_b16 a[204:205], v5 offset:6144
  ds_read_b64_tr_b16 a[206:207], v5 offset:6400
  ds_read_b64_tr_b16 a[208:209], v5 offset:7168
  ds_read_b64_tr_b16 a[210:211], v5 offset:7424
  v_mfma_f32_32x32x16_bf16 v[128:143], a[196:199], v[40:43], v[128:143]
  ds_read_b128 v[36:39], v7 offset:10432
  ds_read_b64_tr_b16 a[212:213], v5 offset:8192
  ds_read_b64_tr_b16 a[214:215], v5 offset:8448
  s_waitcnt lgkmcnt(9)
  v_mfma_f32_32x32x16_bf16 v[160:175], a[192:195], v[44:47], v[160:175]
  s_add_u32 m0, s54, 3072
  s_mov_b32 s73, 86016
  buffer_load_dwordx4 v4, s[44:47], s73 offen lds
  v_mfma_f32_32x32x16_bf16 v[144:159], a[196:199], v[44:47], v[144:159]
  buffer_load_dwordx4 v92, s[44:47], s73 offen offset:1024 lds
  v_mfma_f32_32x32x16_bf16 v[128:143], a[200:203], v[44:47], v[128:143]
  ds_read_b128 v[40:43], v7 offset:576
  buffer_load_dwordx4 v93, s[44:47], s73 offen offset:2048 lds
  v_mfma_f32_32x32x16_bf16 v[128:143], a[192:195], v[48:51], v[128:143]
  ds_read_b128 v[44:47], v7 offset:5536
  s_waitcnt lgkmcnt(9)
  v_mfma_f32_32x32x16_bf16 v[176:191], a[56:59], v[52:55], v[176:191]
  ds_read_b128 v[48:51], v7 offset:10464
  s_waitcnt vmcnt(9)
  ds_read_b64_tr_b16 a[216:217], v5 offset:9216
  ds_read_b64_tr_b16 a[218:219], v5 offset:9472
  s_waitcnt lgkmcnt(8)
  v_mfma_f32_32x32x16_bf16 v[144:159], a[204:207], v[32:35], v[144:159]
  ds_read_b64_tr_b16 a[220:221], v5 offset:10240
  ds_read_b64_tr_b16 a[222:223], v5 offset:10496
  ds_read_b64_tr_b16 a[224:225], v5 offset:11264
  ds_read_b64_tr_b16 a[226:227], v5 offset:11520
  v_mfma_f32_32x32x16_bf16 v[128:143], a[208:211], v[32:35], v[128:143]
  ds_read_b128 v[52:55], v7 offset:608
  s_waitcnt lgkmcnt(10)
  s_add_u32 m0, s54, 6144
  s_mov_b32 s73, 90112
  v_mfma_f32_32x32x16_bf16 v[160:175], a[204:207], v[36:39], v[160:175]
  buffer_load_dwordx4 v4, s[44:47], s73 offen lds
  buffer_load_dwordx4 v92, s[44:47], s73 offen offset:1024 lds
  v_mfma_f32_32x32x16_bf16 v[144:159], a[208:211], v[36:39], v[144:159]
  buffer_load_dwordx4 v93, s[44:47], s73 offen offset:2048 lds
  v_mfma_f32_32x32x16_bf16 v[128:143], a[212:215], v[36:39], v[128:143]
  ds_read_b128 v[32:35], v7 offset:5568
  s_waitcnt lgkmcnt(9)
  v_mfma_f32_32x32x16_bf16 v[128:143], a[204:207], v[40:43], v[128:143]
  ds_read_b128 v[36:39], v7 offset:10496
  s_waitcnt lgkmcnt(5)
  v_mfma_f32_32x32x16_bf16 v[144:159], a[216:219], v[44:47], v[144:159]
  s_waitcnt vmcnt(9)
  ds_read_b64_tr_b16 a[228:229], v5 offset:12288
  ds_read_b64_tr_b16 a[230:231], v5 offset:12544
  ds_read_b64_tr_b16 a[232:233], v5 offset:13312
  ds_read_b64_tr_b16 a[234:235], v5 offset:13568
  v_mfma_f32_32x32x16_bf16 v[128:143], a[220:223], v[44:47], v[128:143]
  ds_read_b128 v[40:43], v7 offset:640
  ds_read_b64_tr_b16 a[236:237], v5 offset:14336
  ds_read_b64_tr_b16 a[238:239], v5 offset:14592
  s_waitcnt lgkmcnt(10)
  v_mfma_f32_32x32x16_bf16 v[160:175], a[216:219], v[48:51], v[160:175]
  s_add_u32 m0, s54, 9216
  s_mov_b32 s73, 94208
  buffer_load_dwordx4 v4, s[44:47], s73 offen lds
  v_mfma_f32_32x32x16_bf16 v[144:159], a[220:223], v[48:51], v[144:159]
  buffer_load_dwordx4 v92, s[44:47], s73 offen offset:1024 lds
  v_mfma_f32_32x32x16_bf16 v[128:143], a[224:227], v[48:51], v[128:143]
  ds_read_b128 v[44:47], v7 offset:5600
  buffer_load_dwordx4 v93, s[44:47], s73 offen offset:2048 lds
  s_waitcnt lgkmcnt(9)
  v_mfma_f32_32x32x16_bf16 v[128:143], a[216:219], v[52:55], v[128:143]
  ds_read_b128 v[48:51], v7 offset:10528
  s_waitcnt lgkmcnt(5)
  v_mfma_f32_32x32x16_bf16 v[144:159], a[228:231], v[32:35], v[144:159]
  s_waitcnt vmcnt(9)
  ds_read_b64_tr_b16 a[240:241], v5 offset:0
  ds_read_b64_tr_b16 a[242:243], v5 offset:256
  ds_read_b64_tr_b16 a[244:245], v5 offset:1024
  ds_read_b64_tr_b16 a[246:247], v5 offset:1280
  v_mfma_f32_32x32x16_bf16 v[128:143], a[232:235], v[32:35], v[128:143]
  ds_read_b128 v[52:55], v7 offset:672
  ds_read_b64_tr_b16 a[248:249], v5 offset:2048
  ds_read_b64_tr_b16 a[250:251], v5 offset:2304
  s_waitcnt lgkmcnt(9)
  v_mfma_f32_32x32x16_bf16 v[160:175], a[228:231], v[36:39], v[160:175]
  s_add_u32 m0, s54, 12288
  s_mov_b32 s73, 0
  buffer_load_dwordx4 v4, s[40:43], s73 offen lds
  v_mfma_f32_32x32x16_bf16 v[144:159], a[232:235], v[36:39], v[144:159]
  buffer_load_dwordx4 v94, s[40:43], s73 offen offset:1024 lds
  v_mfma_f32_32x32x16_bf16 v[128:143], a[236:239], v[36:39], v[128:143]
  ds_read_b128 v[32:35], v7 offset:25072
  buffer_load_dwordx4 v95, s[40:43], s73 offen offset:2048 lds
  v_mfma_f32_32x32x16_bf16 v[128:143], a[228:231], v[40:43], v[128:143]
  ds_read_b128 v[36:39], v7 offset:5632
  s_waitcnt lgkmcnt(5)
  v_mfma_f32_32x32x16_bf16 v[144:159], a[240:243], v[44:47], v[144:159]
  s_waitcnt vmcnt(9)
  ds_read_b64_tr_b16 a[252:253], v5 offset:3072
  ds_read_b64_tr_b16 a[254:255], v5 offset:3328
  ds_read_b64_tr_b16 v[224:225], v5 offset:4096
  ds_read_b64_tr_b16 v[226:227], v5 offset:4352
  v_mfma_f32_32x32x16_bf16 v[128:143], a[244:247], v[44:47], v[128:143]
  ds_read_b128 v[40:43], v7 offset:10560
  ds_read_b64_tr_b16 v[228:229], v5 offset:5120
  ds_read_b64_tr_b16 v[230:231], v5 offset:5376
  s_waitcnt lgkmcnt(9)
  v_mfma_f32_32x32x16_bf16 v[160:175], a[240:243], v[48:51], v[160:175]
  s_add_u32 m0, s54, 0
  s_mov_b32 s73, 12288
  buffer_load_dwordx4 v4, s[40:43], s73 offen lds
  v_mfma_f32_32x32x16_bf16 v[144:159], a[244:247], v[48:51], v[144:159]
  buffer_load_dwordx4 v94, s[40:43], s73 offen offset:1024 lds
  v_mfma_f32_32x32x16_bf16 v[128:143], a[248:251], v[48:51], v[128:143]
  ds_read_b128 v[44:47], v7 offset:704
  buffer_load_dwordx4 v95, s[40:43], s73 offen offset:2048 lds
  v_mfma_f32_32x32x16_bf16 v[128:143], a[240:243], v[52:55], v[128:143]
  ds_read_b128 v[48:51], v7 offset:5664
  s_waitcnt lgkmcnt(9)
  v_mfma_f32_32x32x16_bf16 v[176:191], a[68:71], v[32:35], v[176:191]
  ds_read_b128 v[52:55], v7 offset:10592
  s_waitcnt vmcnt(9)
  ds_read_b64_tr_b16 v[232:233], v5 offset:6144
  ds_read_b64_tr_b16 v[234:235], v5 offset:6400
  s_waitcnt lgkmcnt(8)
  v_mfma_f32_32x32x16_bf16 v[144:159], a[252:255], v[36:39], v[144:159]
  ds_read_b64_tr_b16 v[236:237], v5 offset:7168
  ds_read_b64_tr_b16 v[238:239], v5 offset:7424
  ds_read_b64_tr_b16 v[240:241], v5 offset:8192
  ds_read_b64_tr_b16 v[242:243], v5 offset:8448
  v_mfma_f32_32x32x16_bf16 v[128:143], v[224:227], v[36:39], v[128:143]
  ds_read_b128 v[32:35], v7 offset:736
  s_waitcnt lgkmcnt(10)
  s_add_u32 m0, s54, 3072
  s_mov_b32 s73, 24576
  v_mfma_f32_32x32x16_bf16 v[160:175], a[252:255], v[40:43], v[160:175]
  buffer_load_dwordx4 v4, s[40:43], s73 offen lds
  buffer_load_dwordx4 v94, s[40:43], s73 offen offset:1024 lds
  s_add_u32 m0, s56, 0
  s_nop 0
  buffer_load_dwordx4 v2, s[20:23], s66 offen nt lds
  buffer_load_dwordx4 v3, s[20:23], s66 offen offset:1024 nt lds
  s_add_u32 m0, s56, 8192
  s_nop 0
  buffer_load_dwordx4 v2, s[20:23], s67 offen nt lds
  buffer_load_dwordx4 v3, s[20:23], s67 offen offset:1024 nt lds
  s_add_u32 m0, s56, 16384
  s_nop 0
  buffer_load_dwordx4 v2, s[20:23], s68 offen nt lds
  buffer_load_dwordx4 v3, s[20:23], s68 offen offset:1024 nt lds
  s_add_u32 m0, s56, 24576
  s_nop 0
  buffer_load_dwordx4 v2, s[20:23], s69 offen nt lds
  buffer_load_dwordx4 v3, s[20:23], s69 offen offset:1024 nt lds
  v_mfma_f32_32x32x16_bf16 v[144:159], v[224:227], v[40:43], v[144:159]
  v_mfma_f32_32x32x16_bf16 v[128:143], v[228:231], v[40:43], v[128:143]
  ds_read_b128 v[36:39], v7 offset:5696
  s_waitcnt lgkmcnt(9)
  v_mfma_f32_32x32x16_bf16 v[128:143], a[252:255], v[44:47], v[128:143]
  ds_read_b128 v[40:43], v7 offset:10624
  s_waitcnt lgkmcnt(5)
  v_mfma_f32_32x32x16_bf16 v[144:159], v[232:235], v[48:51], v[144:159]
  s_waitcnt vmcnt(16)
  ds_read_b64_tr_b16 v[244:245], v5 offset:9216
  ds_read_b64_tr_b16 v[246:247], v5 offset:9472
  ds_read_b64_tr_b16 v[248:249], v5 offset:10240
  ds_read_b64_tr_b16 v[250:251], v5 offset:10496
  v_mfma_f32_32x32x16_bf16 v[128:143], v[236:239], v[48:51], v[128:143]
  ds_read_b128 v[44:47], v7 offset:768
  ds_read_b64_tr_b16 v[252:253], v5 offset:11264
  ds_read_b64_tr_b16 v[254:255], v5 offset:11520
  s_waitcnt lgkmcnt(10)
  v_mfma_f32_32x32x16_bf16 v[160:175], v[232:235], v[52:55], v[160:175]
  v_mfma_f32_32x32x16_bf16 v[144:159], v[236:239], v[52:55], v[144:159]
  v_mfma_f32_32x32x16_bf16 v[128:143], v[240:243], v[52:55], v[128:143]
  ds_read_b128 v[48:51], v7 offset:25104
  s_waitcnt lgkmcnt(9)
  v_mfma_f32_32x32x16_bf16 v[128:143], v[232:235], v[32:35], v[128:143]
  ds_read_b128 v[52:55], v7 offset:25136
  s_waitcnt lgkmcnt(5)
  v_mfma_f32_32x32x16_bf16 v[144:159], v[244:247], v[36:39], v[144:159]
  s_waitcnt vmcnt(13)
  ds_read_b64_tr_b16 v[192:193], v5 offset:12288
  ds_read_b64_tr_b16 v[194:195], v5 offset:12544
  ds_read_b64_tr_b16 v[196:197], v5 offset:13312
  ds_read_b64_tr_b16 v[198:199], v5 offset:13568
  v_mfma_f32_32x32x16_bf16 v[128:143], v[248:251], v[36:39], v[128:143]
  ds_read_b128 v[32:35], v7 offset:24640
  ds_read_b64_tr_b16 v[200:201], v5 offset:14336
  ds_read_b64_tr_b16 v[202:203], v5 offset:14592
  s_waitcnt lgkmcnt(9)
  v_mfma_f32_32x32x16_bf16 v[160:175], v[244:247], v[40:43], v[160:175]
  v_mfma_f32_32x32x16_bf16 v[144:159], v[248:251], v[40:43], v[144:159]
  v_mfma_f32_32x32x16_bf16 v[128:143], v[252:255], v[40:43], v[128:143]
  ds_read_b128 v[36:39], v7 offset:24672
  v_mfma_f32_32x32x16_bf16 v[128:143], v[244:247], v[44:47], v[128:143]
  ds_read_b128 v[40:43], v7 offset:24704
  s_nop 10
  v_cvt_pk_bf16_f32 v68, v128, v129
  v_cvt_pk_bf16_f32 v69, v130, v131
  v_cvt_pk_bf16_f32 v70, v132, v133
  v_cvt_pk_bf16_f32 v71, v134, v135
  s_waitcnt lgkmcnt(9)
  v_mfma_f32_32x32x16_bf16 v[176:191], a[80:83], v[48:51], v[176:191]
  ds_read_b128 v[44:47], v7 offset:24736
  ds_write_b128 v21, v[68:71] offset:32768
  v_mfma_f32_32x32x16_bf16 v[176:191], a[92:95], v[52:55], v[176:191]
  ds_read_b128 v[48:51], v7 offset:24768
  v_cvt_pk_bf16_f32 v72, v136, v137
  v_cvt_pk_bf16_f32 v73, v138, v139
  v_cvt_pk_bf16_f32 v74, v140, v141
  v_cvt_pk_bf16_f32 v75, v142, v143
  s_waitcnt lgkmcnt(4)
  v_mfma_f32_32x32x16_bf16 v[176:191], a[104:107], v[32:35], v[176:191]
  ds_read_b128 v[52:55], v7 offset:24800
  ds_write_b128 v22, v[72:75] offset:32768
  v_mfma_f32_32x32x16_bf16 v[176:191], a[116:119], v[36:39], v[176:191]
  ds_read_b128 v[32:35], v7 offset:24832
  s_waitcnt vmcnt(10)
  ds_read_b64_tr_b16 v[204:205], v5 offset:0
  ds_read_b64_tr_b16 v[206:207], v5 offset:256
  s_waitcnt lgkmcnt(7)
  v_mfma_f32_32x32x16_bf16 v[176:191], a[128:131], v[40:43], v[176:191]
  ds_read_b128 v[36:39], v7 offset:24864
  ds_read_b64_tr_b16 v[208:209], v5 offset:1024
  ds_read_b64_tr_b16 v[210:211], v5 offset:1280
  v_mfma_f32_32x32x16_bf16 v[176:191], a[140:143], v[44:47], v[176:191]
  ds_read_b128 v[40:43], v7 offset:25184
  ds_read_b64_tr_b16 v[212:213], v5 offset:2048
  ds_read_b64_tr_b16 v[214:215], v5 offset:2304
  s_waitcnt lgkmcnt(10)
  v_mfma_f32_32x32x16_bf16 v[176:191], a[152:155], v[48:51], v[176:191]
  ds_read_b128 v[44:47], v7 offset:25216
  s_waitcnt vmcnt(8)
  ds_read_b64_tr_b16 v[216:217], v5 offset:3072
  ds_read_b64_tr_b16 v[218:219], v5 offset:3328
  v_mfma_f32_32x32x16_bf16 v[176:191], a[164:167], v[52:55], v[176:191]
  ds_read_b128 v[48:51], v7 offset:25248
  ds_read_b64_tr_b16 v[220:221], v5 offset:4096
  ds_read_b64_tr_b16 v[222:223], v5 offset:4352
  s_waitcnt lgkmcnt(11)
  v_mfma_f32_32x32x16_bf16 v[176:191], a[176:179], v[32:35], v[176:191]
  v_mfma_f32_32x32x16_bf16 v[176:191], a[188:191], v[36:39], v[176:191]
  s_waitcnt lgkmcnt(5)
  v_mfma_f32_32x32x16_bf16 v[176:191], a[200:203], v[40:43], v[176:191]
  v_mfma_f32_32x32x16_bf16 v[176:191], a[212:215], v[44:47], v[176:191]
  s_waitcnt lgkmcnt(2)
  v_mfma_f32_32x32x16_bf16 v[176:191], a[224:227], v[48:51], v[176:191]
  s_waitcnt vmcnt(6)
  s_barrier
  ds_read_b128 v[52:55], v8 offset:32768
  ds_read_b128 v[32:35], v9 offset:32768
  ds_read_b128 v[36:39], v10 offset:32768
  ds_read_b128 v[40:43], v11 offset:32768
  ds_read_b128 v[44:47], v12 offset:32768
  s_waitcnt lgkmcnt(3)
  v_mfma_f32_32x32x16_bf16 v[112:127], v[192:195], v[52:55], 0
  ds_read_b128 v[48:51], v13 offset:32768
  v_mfma_f32_32x32x16_bf16 v[112:127], v[196:199], v[32:35], v[112:127]
  ds_read_b128 v[52:55], v14 offset:32768
  s_waitcnt lgkmcnt(3)
  v_mfma_f32_32x32x16_bf16 v[112:127], v[200:203], v[36:39], v[112:127]
  ds_read_b128 v[32:35], v15 offset:32768
  v_mfma_f32_32x32x16_bf16 v[112:127], v[204:207], v[40:43], v[112:127]
  ds_read_b128 v[36:39], v21 offset:0
  s_waitcnt lgkmcnt(3)
  v_mfma_f32_32x32x16_bf16 v[112:127], v[208:211], v[44:47], v[112:127]
  ds_read_b128 v[40:43], v22 offset:0
  v_mfma_f32_32x32x16_bf16 v[112:127], v[212:215], v[48:51], v[112:127]
  ds_read_b128 v[44:47], v7 offset:25280
  s_waitcnt lgkmcnt(3)
  v_mfma_f32_32x32x16_bf16 v[112:127], v[216:219], v[52:55], v[112:127]
  ds_read_b128 v[48:51], v7 offset:25312
  v_mfma_f32_32x32x16_bf16 v[112:127], v[220:223], v[32:35], v[112:127]
  ds_read_b128 v[52:55], v7 offset:25344
  s_waitcnt lgkmcnt(3)
  v_mfma_f32_32x32x16_bf16 v[112:127], v[56:59], v[36:39], v[112:127]
  ds_read_b128 v[32:35], v7 offset:25376
  v_mfma_f32_32x32x16_bf16 v[112:127], v[60:63], v[40:43], v[112:127]
  ds_read_b128 v[36:39], v7 offset:25408
  s_waitcnt lgkmcnt(3)
  v_mfma_f32_32x32x16_bf16 v[176:191], a[236:239], v[44:47], v[176:191]
  ds_read_b128 v[40:43], v7 offset:14784
  v_mfma_f32_32x32x16_bf16 v[176:191], a[248:251], v[48:51], v[176:191]
  ds_read_b128 v[44:47], v7 offset:14816
  s_nop 5
  v_cvt_pk_bf16_f32 v76, v112, v113
  v_cvt_pk_bf16_f32 v77, v114, v115
  v_cvt_pk_bf16_f32 v78, v116, v117
  v_cvt_pk_bf16_f32 v79, v118, v119
  s_waitcnt lgkmcnt(3)
  v_mfma_f32_32x32x16_bf16 v[176:191], v[228:231], v[52:55], v[176:191]
  ds_read_b128 v[48:51], v7 offset:14848
  ds_write_b128 v21, v[76:79] offset:0
  v_mfma_f32_32x32x16_bf16 v[176:191], v[240:243], v[32:35], v[176:191]
  ds_read_b128 v[52:55], v7 offset:14880
  v_cvt_pk_bf16_f32 v80, v120, v121
  v_cvt_pk_bf16_f32 v81, v122, v123
  v_cvt_pk_bf16_f32 v82, v124, v125
  v_cvt_pk_bf16_f32 v83, v126, v127
  s_waitcnt lgkmcnt(4)
  v_mfma_f32_32x32x16_bf16 v[176:191], v[252:255], v[36:39], v[176:191]
  ds_read_b128 v[32:35], v7 offset:14912
  ds_write_b128 v22, v[80:83] offset:0
  v_mfma_f32_32x32x16_bf16 v[176:191], a[96:99], v[40:43], v[176:191]
  v_mfma_f32_32x32x16_bf16 v[160:175], a[100:103], v[40:43], v[160:175]
  v_mfma_f32_32x32x16_bf16 v[144:159], a[104:107], v[40:43], v[144:159]
  ds_read_b128 v[36:39], v7 offset:14944
  s_waitcnt lgkmcnt(5)
  v_mfma_f32_32x32x16_bf16 v[176:191], a[108:111], v[44:47], v[176:191]
  v_mfma_f32_32x32x16_bf16 v[160:175], a[112:115], v[44:47], v[160:175]
  v_mfma_f32_32x32x16_bf16 v[144:159], a[116:119], v[44:47], v[144:159]
  ds_read_b128 v[40:43], v7 offset:14976
  v_mfma_f32_32x32x16_bf16 v[176:191], a[120:123], v[48:51], v[176:191]
  v_mfma_f32_32x32x16_bf16 v[160:175], a[124:127], v[48:51], v[160:175]
  v_mfma_f32_32x32x16_bf16 v[144:159], a[128:131], v[48:51], v[144:159]
  ds_read_b128 v[44:47], v7 offset:15008
  s_waitcnt lgkmcnt(4)
  v_mfma_f32_32x32x16_bf16 v[176:191], a[132:135], v[52:55], v[176:191]
  v_mfma_f32_32x32x16_bf16 v[160:175], a[136:139], v[52:55], v[160:175]
  v_mfma_f32_32x32x16_bf16 v[144:159], a[140:143], v[52:55], v[144:159]
  ds_read_b128 v[48:51], v7 offset:15328
  v_mfma_f32_32x32x16_bf16 v[176:191], a[144:147], v[32:35], v[176:191]
  v_mfma_f32_32x32x16_bf16 v[160:175], a[148:151], v[32:35], v[160:175]
  v_mfma_f32_32x32x16_bf16 v[144:159], a[152:155], v[32:35], v[144:159]
  ds_read_b128 v[52:55], v7 offset:15360
  s_waitcnt lgkmcnt(3)
  v_mfma_f32_32x32x16_bf16 v[176:191], a[156:159], v[36:39], v[176:191]
  v_mfma_f32_32x32x16_bf16 v[160:175], a[160:163], v[36:39], v[160:175]
  v_mfma_f32_32x32x16_bf16 v[144:159], a[164:167], v[36:39], v[144:159]
  ds_read_b128 v[32:35], v7 offset:15392
  v_mfma_f32_32x32x16_bf16 v[176:191], a[168:171], v[40:43], v[176:191]
  v_mfma_f32_32x32x16_bf16 v[160:175], a[172:175], v[40:43], v[160:175]
  v_mfma_f32_32x32x16_bf16 v[144:159], a[176:179], v[40:43], v[144:159]
  ds_read_b128 v[36:39], v7 offset:15424
  s_waitcnt lgkmcnt(3)
  v_mfma_f32_32x32x16_bf16 v[176:191], a[180:183], v[44:47], v[176:191]
  v_mfma_f32_32x32x16_bf16 v[160:175], a[184:187], v[44:47], v[160:175]
  v_mfma_f32_32x32x16_bf16 v[144:159], a[188:191], v[44:47], v[144:159]
  ds_read_b128 v[40:43], v7 offset:15456
  v_mfma_f32_32x32x16_bf16 v[176:191], a[192:195], v[48:51], v[176:191]
  v_mfma_f32_32x32x16_bf16 v[160:175], a[196:199], v[48:51], v[160:175]
  v_mfma_f32_32x32x16_bf16 v[144:159], a[200:203], v[48:51], v[144:159]
  ds_read_b128 v[44:47], v7 offset:15488
  s_waitcnt lgkmcnt(3)
  v_mfma_f32_32x32x16_bf16 v[176:191], a[204:207], v[52:55], v[176:191]
  v_mfma_f32_32x32x16_bf16 v[160:175], a[208:211], v[52:55], v[160:175]
  v_mfma_f32_32x32x16_bf16 v[144:159], a[212:215], v[52:55], v[144:159]
  ds_read_b128 v[48:51], v7 offset:15520
  v_mfma_f32_32x32x16_bf16 v[176:191], a[216:219], v[32:35], v[176:191]
  v_mfma_f32_32x32x16_bf16 v[160:175], a[220:223], v[32:35], v[160:175]
  v_mfma_f32_32x32x16_bf16 v[144:159], a[224:227], v[32:35], v[144:159]
  ds_read_b128 v[52:55], v7 offset:15552
  s_waitcnt lgkmcnt(3)
  v_mfma_f32_32x32x16_bf16 v[176:191], a[228:231], v[36:39], v[176:191]
  v_mfma_f32_32x32x16_bf16 v[160:175], a[232:235], v[36:39], v[160:175]
  v_mfma_f32_32x32x16_bf16 v[144:159], a[236:239], v[36:39], v[144:159]
  ds_read_b128 v[32:35], v7 offset:19712
  v_mfma_f32_32x32x16_bf16 v[176:191], a[240:243], v[40:43], v[176:191]
  v_mfma_f32_32x32x16_bf16 v[160:175], a[244:247], v[40:43], v[160:175]
  v_mfma_f32_32x32x16_bf16 v[144:159], a[248:251], v[40:43], v[144:159]
  ds_read_b128 v[36:39], v7 offset:19744
  s_waitcnt lgkmcnt(3)
  v_mfma_f32_32x32x16_bf16 v[176:191], a[252:255], v[44:47], v[176:191]
  v_mfma_f32_32x32x16_bf16 v[160:175], v[224:227], v[44:47], v[160:175]
  v_mfma_f32_32x32x16_bf16 v[144:159], v[228:231], v[44:47], v[144:159]
  ds_read_b128 v[40:43], v7 offset:19776
  v_mfma_f32_32x32x16_bf16 v[176:191], v[232:235], v[48:51], v[176:191]
  v_mfma_f32_32x32x16_bf16 v[160:175], v[236:239], v[48:51], v[160:175]
  v_mfma_f32_32x32x16_bf16 v[144:159], v[240:243], v[48:51], v[144:159]
  ds_read_b128 v[44:47], v7 offset:19808
  s_waitcnt lgkmcnt(3)
  v_mfma_f32_32x32x16_bf16 v[176:191], v[244:247], v[52:55], v[176:191]
  v_mfma_f32_32x32x16_bf16 v[160:175], v[248:251], v[52:55], v[160:175]
  v_mfma_f32_32x32x16_bf16 v[144:159], v[252:255], v[52:55], v[144:159]
  ds_read_b128 v[48:51], v7 offset:19840
  s_nop 10
  v_cvt_pk_bf16_f32 v68, v144, v145
  v_cvt_pk_bf16_f32 v69, v146, v147
  v_cvt_pk_bf16_f32 v70, v148, v149
  v_cvt_pk_bf16_f32 v71, v150, v151
  v_mfma_f32_32x32x16_bf16 v[176:191], a[100:103], v[32:35], v[176:191]
  ds_write_b128 v21, v[68:71] offset:40960
  v_cvt_pk_bf16_f32 v72, v152, v153
  v_cvt_pk_bf16_f32 v73, v154, v155
  v_cvt_pk_bf16_f32 v74, v156, v157
  v_mfma_f32_32x32x16_bf16 v[160:175], a[104:107], v[32:35], v[160:175]
  v_cvt_pk_bf16_f32 v75, v158, v159
  ds_write_b128 v22, v[72:75] offset:40960
  s_waitcnt lgkmcnt(4)
  v_mfma_f32_32x32x16_bf16 v[176:191], a[112:115], v[36:39], v[176:191]
  v_mfma_f32_32x32x16_bf16 v[160:175], a[116:119], v[36:39], v[160:175]
  v_mfma_f32_32x32x16_bf16 v[176:191], a[124:127], v[40:43], v[176:191]
  v_mfma_f32_32x32x16_bf16 v[160:175], a[128:131], v[40:43], v[160:175]
  s_waitcnt lgkmcnt(2)
  v_mfma_f32_32x32x16_bf16 v[176:191], a[136:139], v[44:47], v[176:191]
  v_mfma_f32_32x32x16_bf16 v[160:175], a[140:143], v[44:47], v[160:175]
  v_mfma_f32_32x32x16_bf16 v[176:191], a[148:151], v[48:51], v[176:191]
  v_mfma_f32_32x32x16_bf16 v[160:175], a[152:155], v[48:51], v[160:175]
  s_waitcnt vmcnt(4) lgkmcnt(0)
  s_barrier
  ds_read_b128 v[52:55], v8 offset:40960
  ds_read_b128 v[32:35], v9 offset:40960
  ds_read_b128 v[36:39], v10 offset:40960
  ds_read_b128 v[40:43], v11 offset:40960
  ds_read_b128 v[44:47], v12 offset:40960
  s_waitcnt lgkmcnt(3)
  v_mfma_f32_32x32x16_bf16 v[112:127], v[192:195], v[52:55], 0
  ds_read_b128 v[48:51], v13 offset:40960
  ds_read_b128 v[84:87], v1 offset:0
  ds_read_b128 v[88:91], v1 offset:1024
  v_mfma_f32_32x32x16_bf16 v[112:127], v[196:199], v[32:35], v[112:127]
  ds_read_b128 v[52:55], v14 offset:40960
  s_waitcnt lgkmcnt(5)
  v_mfma_f32_32x32x16_bf16 v[112:127], v[200:203], v[36:39], v[112:127]
  ds_read_b128 v[32:35], v15 offset:40960
  v_mfma_f32_32x32x16_bf16 v[112:127], v[204:207], v[40:43], v[112:127]
  ds_read_b128 v[36:39], v21 offset:8192
  s_waitcnt lgkmcnt(4)
  buffer_store_dwordx4 v[84:87], v2, s[32:35], s66 offen nt
  s_waitcnt lgkmcnt(3)
  buffer_store_dwordx4 v[88:91], v3, s[32:35], s66 offen offset:1024 nt
  v_mfma_f32_32x32x16_bf16 v[112:127], v[208:211], v[44:47], v[112:127]
  ds_read_b128 v[40:43], v22 offset:8192
  v_mfma_f32_32x32x16_bf16 v[112:127], v[212:215], v[48:51], v[112:127]
  ds_read_b128 v[44:47], v7 offset:19872
  s_waitcnt lgkmcnt(3)
  v_mfma_f32_32x32x16_bf16 v[112:127], v[216:219], v[52:55], v[112:127]
  ds_read_b128 v[48:51], v7 offset:19904
  v_mfma_f32_32x32x16_bf16 v[112:127], v[220:223], v[32:35], v[112:127]
  ds_read_b128 v[52:55], v7 offset:19936
  s_waitcnt lgkmcnt(3)
  v_mfma_f32_32x32x16_bf16 v[112:127], v[56:59], v[36:39], v[112:127]
  ds_read_b128 v[32:35], v7 offset:20256
  v_mfma_f32_32x32x16_bf16 v[112:127], v[60:63], v[40:43], v[112:127]
  ds_read_b128 v[36:39], v7 offset:20288
  s_waitcnt lgkmcnt(3)
  v_mfma_f32_32x32x16_bf16 v[176:191], a[160:163], v[44:47], v[176:191]
  v_mfma_f32_32x32x16_bf16 v[160:175], a[164:167], v[44:47], v[160:175]
  ds_read_b128 v[40:43], v7 offset:20320
  s_nop 6
  v_cvt_pk_bf16_f32 v76, v112, v113
  v_cvt_pk_bf16_f32 v77, v114, v115
  v_cvt_pk_bf16_f32 v78, v116, v117
  v_cvt_pk_bf16_f32 v79, v118, v119
  v_mfma_f32_32x32x16_bf16 v[176:191], a[172:175], v[48:51], v[176:191]
  ds_write_b128 v21, v[76:79] offset:8192
  v_cvt_pk_bf16_f32 v80, v120, v121
  v_cvt_pk_bf16_f32 v81, v122, v123
  v_cvt_pk_bf16_f32 v82, v124, v125
  v_mfma_f32_32x32x16_bf16 v[160:175], a[176:179], v[48:51], v[160:175]
  ds_read_b128 v[44:47], v7 offset:20352
  v_cvt_pk_bf16_f32 v83, v126, v127
  ds_write_b128 v22, v[80:83] offset:8192
  s_waitcnt lgkmcnt(5)
  v_mfma_f32_32x32x16_bf16 v[176:191], a[184:187], v[52:55], v[176:191]
  v_mfma_f32_32x32x16_bf16 v[160:175], a[188:191], v[52:55], v[160:175]
  ds_read_b128 v[48:51], v7 offset:20384
  v_mfma_f32_32x32x16_bf16 v[176:191], a[196:199], v[32:35], v[176:191]
  v_mfma_f32_32x32x16_bf16 v[160:175], a[200:203], v[32:35], v[160:175]
  ds_read_b128 v[52:55], v7 offset:20416
  s_waitcnt lgkmcnt(5)
  v_mfma_f32_32x32x16_bf16 v[176:191], a[208:211], v[36:39], v[176:191]
  v_mfma_f32_32x32x16_bf16 v[160:175], a[212:215], v[36:39], v[160:175]
  ds_read_b128 v[32:35], v7 offset:20448
  v_mfma_f32_32x32x16_bf16 v[176:191], a[220:223], v[40:43], v[176:191]
  v_mfma_f32_32x32x16_bf16 v[160:175], a[224:227], v[40:43], v[160:175]
  ds_read_b128 v[36:39], v7 offset:20480
  s_waitcnt lgkmcnt(3)
  v_mfma_f32_32x32x16_bf16 v[176:191], a[232:235], v[44:47], v[176:191]
  v_mfma_f32_32x32x16_bf16 v[160:175], a[236:239], v[44:47], v[160:175]
  v_mfma_f32_32x32x16_bf16 v[176:191], a[244:247], v[48:51], v[176:191]
  v_mfma_f32_32x32x16_bf16 v[160:175], a[248:251], v[48:51], v[160:175]
  s_waitcnt lgkmcnt(2)
  v_mfma_f32_32x32x16_bf16 v[176:191], v[224:227], v[52:55], v[176:191]
  v_mfma_f32_32x32x16_bf16 v[160:175], v[228:231], v[52:55], v[160:175]
  s_waitcnt lgkmcnt(1)
  v_mfma_f32_32x32x16_bf16 v[176:191], v[236:239], v[32:35], v[176:191]
  v_mfma_f32_32x32x16_bf16 v[160:175], v[240:243], v[32:35], v[160:175]
  s_waitcnt lgkmcnt(0)
  v_mfma_f32_32x32x16_bf16 v[176:191], v[248:251], v[36:39], v[176:191]
  v_mfma_f32_32x32x16_bf16 v[160:175], v[252:255], v[36:39], v[160:175]
  s_nop 11
  v_cvt_pk_bf16_f32 v68, v160, v161
  v_cvt_pk_bf16_f32 v69, v162, v163
  v_cvt_pk_bf16_f32 v70, v164, v165
  v_cvt_pk_bf16_f32 v71, v166, v167
  ds_write_b128 v21, v[68:71] offset:32768
  v_cvt_pk_bf16_f32 v72, v168, v169
  v_cvt_pk_bf16_f32 v73, v170, v171
  v_cvt_pk_bf16_f32 v74, v172, v173
  v_cvt_pk_bf16_f32 v75, v174, v175
  ds_write_b128 v22, v[72:75] offset:32768
  v_add_u32 v224, 100480, v8
  v_add_u32 v225, 100480, v9
  v_add_u32 v226, 100480, v10
  v_add_u32 v227, 100480, v11
  v_add_u32 v228, 100480, v12
  v_add_u32 v229, 100480, v13
  v_add_u32 v230, 100480, v14
  v_add_u32 v231, 100480, v15
  v_add_u32 v232, 100480, v21
  v_cvt_pk_bf16_f32 v84, v176, v177
  v_cvt_pk_bf16_f32 v85, v178, v179
  v_cvt_pk_bf16_f32 v86, v180, v181
  v_cvt_pk_bf16_f32 v87, v182, v183
  ds_write_b128 v232, v[84:87] offset:0
  v_add_u32 v233, 100480, v22
  v_cvt_pk_bf16_f32 v88, v184, v185
  v_cvt_pk_bf16_f32 v89, v186, v187
  v_cvt_pk_bf16_f32 v90, v188, v189
  v_cvt_pk_bf16_f32 v91, v190, v191
  ds_write_b128 v233, v[88:91] offset:0
  s_waitcnt vmcnt(2) lgkmcnt(0)
  s_barrier
  ds_read_b128 v[40:43], v8 offset:32768
  ds_read_b128 v[44:47], v9 offset:32768
  ds_read_b128 v[48:51], v10 offset:32768
  ds_read_b128 v[52:55], v11 offset:32768
  ds_read_b128 v[32:35], v12 offset:32768
  s_waitcnt lgkmcnt(3)
  v_mfma_f32_32x32x16_bf16 v[112:127], v[192:195], v[40:43], 0
  ds_read_b128 v[36:39], v13 offset:32768
  ds_read_b128 v[68:71], v1 offset:8192
  ds_read_b128 v[72:75], v1 offset:9216
  v_mfma_f32_32x32x16_bf16 v[112:127], v[196:199], v[44:47], v[112:127]
  ds_read_b128 v[40:43], v224 offset:0
  s_waitcnt lgkmcnt(5)
  v_mfma_f32_32x32x16_bf16 v[112:127], v[200:203], v[48:51], v[112:127]
  ds_read_b128 v[44:47], v14 offset:32768
  s_waitcnt lgkmcnt(3)
  buffer_store_dwordx4 v[68:71], v2, s[32:35], s67 offen nt
  s_waitcnt lgkmcnt(2)
  buffer_store_dwordx4 v[72:75], v3, s[32:35], s67 offen offset:1024 nt
  v_mfma_f32_32x32x16_bf16 v[112:127], v[204:207], v[52:55], v[112:127]
  ds_read_b128 v[48:51], v225 offset:0
  v_mfma_f32_32x32x16_bf16 v[112:127], v[208:211], v[32:35], v[112:127]
  ds_read_b128 v[52:55], v15 offset:32768
  v_mfma_f32_32x32x16_bf16 v[112:127], v[212:215], v[36:39], v[112:127]
  ds_read_b128 v[32:35], v226 offset:0
  s_waitcnt lgkmcnt(3)
  v_mfma_f32_32x32x16_bf16 v[96:111], v[192:195], v[40:43], 0
  ds_read_b128 v[36:39], v21 offset:16384
  v_mfma_f32_32x32x16_bf16 v[112:127], v[216:219], v[44:47], v[112:127]
  ds_read_b128 v[40:43], v227 offset:0
  s_waitcnt lgkmcnt(3)
  v_mfma_f32_32x32x16_bf16 v[96:111], v[196:199], v[48:51], v[96:111]
  ds_read_b128 v[44:47], v22 offset:16384
  v_mfma_f32_32x32x16_bf16 v[112:127], v[220:223], v[52:55], v[112:127]
  ds_read_b128 v[48:51], v228 offset:0
  s_waitcnt lgkmcnt(3)
  v_mfma_f32_32x32x16_bf16 v[96:111], v[200:203], v[32:35], v[96:111]
  ds_read_b128 v[52:55], v229 offset:0
  v_mfma_f32_32x32x16_bf16 v[112:127], v[56:59], v[36:39], v[112:127]
  ds_read_b128 v[32:35], v230 offset:0
  s_waitcnt lgkmcnt(3)
  v_mfma_f32_32x32x16_bf16 v[96:111], v[204:207], v[40:43], v[96:111]
  ds_read_b128 v[36:39], v231 offset:0
  v_mfma_f32_32x32x16_bf16 v[112:127], v[60:63], v[44:47], v[112:127]
  ds_read_b128 v[40:43], v21 offset:24576
  s_waitcnt lgkmcnt(3)
  v_mfma_f32_32x32x16_bf16 v[96:111], v[208:211], v[48:51], v[96:111]
  ds_read_b128 v[44:47], v22 offset:24576
  v_mfma_f32_32x32x16_bf16 v[96:111], v[212:215], v[52:55], v[96:111]
  s_waitcnt lgkmcnt(2)
  v_mfma_f32_32x32x16_bf16 v[96:111], v[216:219], v[32:35], v[96:111]
  s_nop 4
  v_cvt_pk_bf16_f32 v76, v112, v113
  v_cvt_pk_bf16_f32 v77, v114, v115
  v_cvt_pk_bf16_f32 v78, v116, v117
  v_cvt_pk_bf16_f32 v79, v118, v119
  ds_write_b128 v21, v[76:79] offset:16384
  v_cvt_pk_bf16_f32 v80, v120, v121
  v_cvt_pk_bf16_f32 v81, v122, v123
  v_cvt_pk_bf16_f32 v82, v124, v125
  v_cvt_pk_bf16_f32 v83, v126, v127
  v_mfma_f32_32x32x16_bf16 v[96:111], v[220:223], v[36:39], v[96:111]
  ds_write_b128 v22, v[80:83] offset:16384
  s_waitcnt lgkmcnt(2)
  v_mfma_f32_32x32x16_bf16 v[96:111], v[56:59], v[40:43], v[96:111]
  v_mfma_f32_32x32x16_bf16 v[96:111], v[60:63], v[44:47], v[96:111]
  s_nop 11
  v_cvt_pk_bf16_f32 v84, v96, v97
  v_cvt_pk_bf16_f32 v85, v98, v99
  v_cvt_pk_bf16_f32 v86, v100, v101
  v_cvt_pk_bf16_f32 v87, v102, v103
  ds_write_b128 v21, v[84:87] offset:24576
  v_cvt_pk_bf16_f32 v88, v104, v105
  v_cvt_pk_bf16_f32 v89, v106, v107
  v_cvt_pk_bf16_f32 v90, v108, v109
  v_cvt_pk_bf16_f32 v91, v110, v111
  ds_write_b128 v22, v[88:91] offset:24576
  s_waitcnt lgkmcnt(0)
  s_barrier
  ds_read_b128 v[112:115], v1 offset:16384
  ds_read_b128 v[116:119], v1 offset:17408
  ds_read_b128 v[120:123], v1 offset:24576
  ds_read_b128 v[124:127], v1 offset:25600
  s_waitcnt lgkmcnt(3)
  buffer_store_dwordx4 v[112:115], v2, s[32:35], s68 offen nt
  s_waitcnt lgkmcnt(2)
  buffer_store_dwordx4 v[116:119], v3, s[32:35], s68 offen offset:1024 nt
  s_waitcnt lgkmcnt(1)
  buffer_store_dwordx4 v[120:123], v2, s[32:35], s69 offen nt
  s_waitcnt lgkmcnt(0)
  buffer_store_dwordx4 v[124:127], v3, s[32:35], s69 offen offset:1024 nt
L_end:
  s_endpgm
.section .rodata,"a"
.p2align 6
.amdhsa_kernel standalone__controlnet__diffusion_kernel
  .amdhsa_next_free_vgpr 512
  .amdhsa_next_free_sgpr 102
  .amdhsa_accum_offset 256
  .amdhsa_group_segment_fixed_size 0
  .amdhsa_kernarg_size 72
  .amdhsa_user_sgpr_count 2
  .amdhsa_user_sgpr_kernarg_segment_ptr 1
  .amdhsa_system_sgpr_workgroup_id_x 1
.end_amdhsa_kernel
```
